```python
import torch

def _softmax(x, axis=-1):
    return torch.softmax(x, dim=axis)
def _gelu(x):
    return torch.nn.functional.gelu(x, approximate="tanh")
def _silu(x):
    return torch.nn.functional.silu(x)
def _sigmoid(x):
    return torch.sigmoid(x)
def _layernorm(x, axis=-1, eps=1e-5):
    m = x.mean(dim=axis, keepdim=True)
    v = x.var(dim=axis, keepdim=True, unbiased=False)
    return (x - m) / torch.sqrt(v + eps)
def _scatter_add(tgt, idx, src, axis=0):
    return tgt.clone().index_add_(axis, idx, src)
def _segment_sum(src, seg, n):
    out = torch.zeros((n,) + src.shape[1:], dtype=src.dtype)
    return out.index_add_(0, seg, src)
def _pad(x, pw):
    flat = tuple(v for pair in reversed(pw) for v in pair)
    return torch.nn.functional.pad(x, flat)

kernel_name = 'standalone__cross_network_dcn_v2__recsys'

def setup_inputs():

    _w = (lambda a: (lambda t: t.to(torch.bfloat16) if t.is_floating_point() else t)(torch.as_tensor(a)))
    B, F, D, L = 16384, 26, 16, 3
    Din = min(F * D, 512)
    R = max(Din // 4, 2)
    sc = Din ** -0.5
    return {
        "x0": _w((lambda *s: torch.randn(*s, dtype=torch.bfloat16) * 0.05)(B, Din)),
        "U":  _w((lambda *s: torch.randn(*s, dtype=torch.bfloat16) * 1.6)(L, Din, R) * sc),
        "V":  _w((lambda *s: torch.randn(*s, dtype=torch.bfloat16) * 1.6)(L, R, Din) * sc),
        "bs": _w((lambda *s: torch.randn(*s, dtype=torch.bfloat16) * 0.05)(L, Din)),
    }

def reference(x0, U, V, bs):
    x = x0
    for l in range(U.shape[0]):
        h = torch.einsum('rd,bd->br', V[l], x)
        h = torch.einsum('dr,br->bd', U[l], h)
        x = x0 * (h + bs[l]) + x
    return x
```

```asm
; @launch grid=(256,1,1) block=(256,1,1) lds=163840
.amdgcn_target "amdgcn-amd-amdhsa--gfx950"
.text
.globl standalone__cross_network_dcn_v2__recsys_kernel
.p2align 12
.p2align 8
.type standalone__cross_network_dcn_v2__recsys_kernel,@function
standalone__cross_network_dcn_v2__recsys_kernel:
s_load_dwordx4 s[4:7], s[0:1], 0
s_load_dwordx4 s[8:11], s[0:1], 16
s_getpc_b64 s[64:65]
L_pc:
s_mov_b32 s66, L_end-L_pc
s_mov_b32 s67, 0x20000
s_bfe_u32 s68, s2, 0x30003
s_lshl_b32 s68, s68, 7
v_lshlrev_b32 v19, 10, v0
buffer_load_dword v19, v19, s[64:67], s68 offen
s_lshr_b32 s14, s2, 8
s_cbranch_scc1 L_end
v_lshrrev_b32 v2, 6, v0
v_and_b32 v1, 63, v0
v_readfirstlane_b32 s3, v2
v_lshrrev_b32 v3, 3, v1
v_lshlrev_b32 v253, 4, v1
v_and_b32 v5, 6, v3
v_lshlrev_b32 v5, 4, v5
v_xor_b32 v5, v5, v253
s_movk_i32 s14, 1536
v_mad_u32_u24 v8, v3, s14, v5
v_lshrrev_b32 v4, 5, v1
s_movk_i32 s14, 6656
v_mad_u32_u24 v254, v4, s14, v8
s_and_b32 s58, s3, 1
s_lshr_b32 s59, s3, 1
s_lshl_b32 s47, s3, 10
s_lshl_b32 s48, s59, 12
s_add_u32 s48, s48, s47
s_mul_i32 s14, s14, s58
s_mul_i32 s52, s59, 896
s_add_u32 s14, s14, s52
v_add_u32 v254, s14, v254
s_lshl2_add_u32 s15, s2, s3
s_mulk_i32 s15, 13312
s_movk_i32 s18, 13312
s_mov_b32 s19, s67
s_mov_b32 s26, 259584
s_mov_b32 s27, s67
s_mov_b32 s42, 86528
s_mov_b32 s43, s67
s_lshr_b32 s14, s2, 4
s_lshl_b32 s14, s14, 7
s_lshl_b32 s53, s59, 17
s_add_u32 s14, s14, s53
v_lshlrev_b32 v16, 11, v1
s_add_u32 s63, s48, 53248
s_movk_i32 s69, 4096
s_movk_i32 s70, 8192
s_movk_i32 s71, 0
s_movk_i32 s76, 896
s_movk_i32 s77, 768
s_bitcmp1_b32 s2, 3
s_cmovk_i32 s77, 512
s_cmovk_i32 s69, 2048
s_cmovk_i32 s70, 12288
s_cmovk_i32 s76, 26624
s_cselect_b32 s62, s63, s47
s_cselect_b64 s[74:75], s[26:27], s[18:19]
s_cselect_b64 vcc, -1, 0
v_cndmask_b32 v15, v8, v254, vcc
s_cmp_eq_u32 s58, 1
s_waitcnt lgkmcnt(0)
s_cselect_b64 s[40:41], s[6:7], s[8:9]
s_add_u32 s16, s4, s15
s_addc_u32 s17, s5, 0
s_mov_b64 s[24:25], s[8:9]
s_mov_b64 s[72:73], s[16:17]
s_cbranch_vccz L_loop
s_mov_b64 s[72:73], s[8:9]
buffer_load_dword v18, v16, s[40:43], s14 offen
L_loop:
s_mov_b32 m0, s62
s_add_u32 s63, s62, s69
buffer_load_dwordx4 v15, s[72:75], s71 offen lds
s_mov_b32 m0, s63
s_add_u32 s62, s62, s70
buffer_load_dwordx4 v15, s[72:75], s76 offen lds
s_addk_i32 s76, 128
s_addk_i32 s71, 128
s_cmp_lg_u32 s71, s77
s_cbranch_scc1 L_loop
s_lshl_b32 s49, s58, 10
s_mul_i32 s51, s59, 25728
s_add_u32 s51, s51, 768
s_sub_u32 s52, 54016, s52
s_mul_i32 s50, s3, 1664
s_add_u32 s53, s50, 79872
s_mov_b32 s44, 0
s_mov_b32 s45, 26624
s_mov_b32 s46, 53248
s_load_dwordx2 s[12:13], s[0:1], 32
s_add_u32 s14, s14, 86528
s_mov_b32 s42, 259584
s_cmp_eq_u32 s58, 1
s_cselect_b32 s42, 259584, s42
s_mov_b32 s42, 169472
s_mov_b32 s72, s40
s_or_b32 s73, s41, 0x1000000
s_movk_i32 s74, 176
s_mov_b32 s75, s67
s_lshr_b32 s69, s2, 3
s_lshl_b32 s69, s69, 7
s_mul_i32 s70, s59, 45056
s_add_u32 s69, s69, s70
s_add_u32 s69, s69, 169472
s_or_b32 s73, s41, 0x800000
s_lshr_b32 s69, s2, 4
s_lshl_b32 s69, s69, 7
s_add_u32 s69, s69, s70
s_add_u32 s69, s69, 169472
s_bitcmp1_b32 s2, 3
s_cselect_b32 s74, 352, 0
s_mov_b32 s28, s6
s_mov_b32 s29, s7
s_mov_b32 s30, 53248
s_mov_b32 s31, 0x20000
s_add_u32 s32, s6, 159744
s_addc_u32 s33, s7, 0
s_mov_b32 s34, 99840
s_mov_b32 s35, 0x20000
s_mov_b32 s36, s10
s_mov_b32 s37, s11
s_mov_b32 s38, 2496
s_mov_b32 s39, 0x20000
s_mov_b32 s22, 13312
s_mov_b32 s23, 0x20000
s_mov_b32 s54, 0xffff0000
s_mov_b32 s56, -1
s_mov_b32 s57, 0
v_and_b32 v2, 15, v1
v_lshrrev_b32 v3, 4, v1
v_lshlrev_b32 v6, 4, v3
v_mul_u32_u24 v7, 416, v2
v_add_u32 v248, v7, v6
v_and_b32 v13, 1, v3
v_lshl_add_u32 v7, v13, 3, v7
v_add_u32 v249, 192, v7
v_mul_u32_u24 v7, 832, v2
v_add_u32 v255, v7, v6
v_xor_b32 v13, 32, v6
v_cmp_gt_u32 vcc, 8, v2
s_nop 1
v_cndmask_b32 v13, v13, v255, vcc
v_add_u32 v252, 139264, v13
v_mul_u32_u24 v7, 832, v3
v_lshl_add_u32 v7, v2, 2, v7
v_add_u32 v243, 152576, v7
v_lshrrev_b32 v4, 3, v2
v_and_b32 v5, 3, v2
v_lshl_add_u32 v7, v4, 2, v5
v_lshlrev_b32 v7, 7, v7
v_and_b32 v13, 4, v2
v_lshl_add_u32 v7, v13, 8, v7
v_and_b32 v13, 2, v2
v_lshlrev_b32 v13, 4, v13
v_lshl_or_b32 v13, v4, 6, v13
v_xor_b32 v13, v13, v6
v_add_u32 v13, 77824, v13
v_add_u32 v250, v7, v13
v_xor_b32 v251, 64, v250
v_subrev_u32 v20, 24576, v250
v_subrev_u32 v21, 24576, v251
v_lshrrev_b32 v7, 1, v2
v_lshl_add_u32 v7, v7, 7, s47
v_and_b32 v5, 1, v2
v_and_b32 v13, 12, v2
v_lshlrev_b32 v13, 3, v13
v_xor_b32 v13, v13, v6
v_lshlrev_b32 v14, 6, v5
v_xor_b32 v13, v13, v14
v_add_u32 v7, v7, v13
v_mul_u32_u24 v14, 49152, v5
v_add_u32 v9, v7, v14
v_lshlrev_b32 v14, 12, v5
v_sub_u32 v10, v7, v14
v_add_u32 v10, 4096, v10
v_xor_b32 v7, 64, v7
v_add_u32 v11, v7, v14
v_mov_b32 v7, 0x3f80
v_mul_u32_u24 v14, 768, v5
v_sub_u32 v255, v255, v14
s_mov_b32 s62, 0x55555555
s_mov_b32 s63, s62
v_cmp_eq_u32 vcc, 0, v3
s_nop 1
v_cndmask_b32 v13, 0, v7, vcc
v_accvgpr_write_b32 a163, 0
v_accvgpr_write_b32 a166, v13
v_lshlrev_b32 v13, 16, v13
v_accvgpr_write_b32 a167, 0
v_accvgpr_write_b32 a162, v13
v_cmp_eq_u32 vcc, 1, v3
s_nop 1
v_cndmask_b32 v13, 0, v7, vcc
v_accvgpr_write_b32 a169, 0
v_accvgpr_write_b32 a172, v13
v_lshlrev_b32 v13, 16, v13
v_accvgpr_write_b32 a173, 0
v_accvgpr_write_b32 a168, v13
v_cmp_eq_u32 vcc, 2, v3
s_nop 1
v_cndmask_b32 v13, 0, v7, vcc
v_accvgpr_write_b32 a175, 0
v_accvgpr_write_b32 a178, v13
v_lshlrev_b32 v13, 16, v13
v_accvgpr_write_b32 a179, 0
v_accvgpr_write_b32 a174, v13
s_waitcnt lgkmcnt(0)
s_add_u32 s20, s12, s15
s_addc_u32 s21, s13, 0
s_mov_b64 vcc, -1
s_bfe_u32 s77, s2, 0x10003
s_lshl2_add_u32 s77, s77, s3
s_cmp_eq_u32 s77, 0
s_cbranch_scc1 L_pad5
s_cmp_eq_u32 s77, 1
s_cbranch_scc1 L_pad4
s_cmp_eq_u32 s77, 2
s_cbranch_scc1 L_pad1
s_cmp_eq_u32 s77, 3
s_cbranch_scc1 L_M
s_cmp_eq_u32 s77, 4
s_cbranch_scc1 L_pad5
s_cmp_eq_u32 s77, 5
s_cbranch_scc1 L_pad4
s_cmp_eq_u32 s77, 6
s_cbranch_scc1 L_pad3
s_cmp_eq_u32 s77, 7
s_cbranch_scc1 L_B
L_rT:
s_bitcmp1_b32 s2, 3
s_cbranch_scc0 L_A
s_add_u32 m0, s47, 152576
s_nop 0
buffer_load_dwordx4 v253, s[36:39], s47 offen lds
s_add_u32 m0, s47, 126976
s_nop 0
buffer_load_dwordx4 v254, s[24:27], s51 offen lds
s_add_u32 m0, s48, 57344
s_nop 0
buffer_load_dwordx4 v254, s[24:27], s46 offen lds
s_add_u32 m0, s49, 131072
s_nop 0
buffer_load_dwordx4 v254, s[24:27], s52 offen lds
s_add_u32 m0, s50, 139264
s_nop 0
buffer_load_dwordx4 v253, s[24:27], s53 offen lds
buffer_load_dwordx4 v253, s[24:27], s53 offen offset:640 lds
s_add_u32 m0, s48, 69504
s_nop 0
buffer_load_dwordx4 v254, s[24:27], s46 offen offset:128 lds
s_add_u32 m0, s48, 81664
s_nop 0
buffer_load_dwordx4 v254, s[24:27], s46 offen offset:256 lds
s_add_u32 m0, s48, 93824
s_nop 0
buffer_load_dwordx4 v254, s[24:27], s46 offen offset:384 lds
s_add_u32 m0, s48, 101888
s_nop 0
buffer_load_dwordx4 v254, s[24:27], s44 offen offset:512 lds
s_add_u32 m0, s48, 103936
s_nop 0
buffer_load_dwordx4 v254, s[24:27], s45 offen offset:512 lds
s_add_u32 m0, s48, 105984
s_nop 0
buffer_load_dwordx4 v254, s[24:27], s46 offen offset:512 lds
s_add_u32 m0, s48, 114048
s_nop 0
buffer_load_dwordx4 v254, s[24:27], s44 offen offset:640 lds
s_add_u32 m0, s48, 116096
s_nop 0
buffer_load_dwordx4 v254, s[24:27], s45 offen offset:640 lds
s_add_u32 m0, s48, 118144
s_nop 0
buffer_load_dwordx4 v254, s[24:27], s46 offen offset:640 lds
s_mov_b32 m0, s47
s_nop 0
buffer_load_dwordx4 v8, s[16:19], 0 offen lds
s_add_u32 m0, s47, 48384
s_nop 0
buffer_load_dwordx4 v8, s[16:19], 0 offen offset:768 lds
s_add_u32 m0, s47, 3200
s_nop 0
buffer_load_dwordx4 v8, s[16:19], 0 offen offset:896 lds
s_add_u32 m0, s47, 8064
s_nop 0
buffer_load_dwordx4 v8, s[16:19], 0 offen offset:128 lds
s_add_u32 m0, s47, 11264
s_nop 0
buffer_load_dwordx4 v8, s[16:19], 0 offen offset:1024 lds
s_add_u32 m0, s47, 16128
s_nop 0
buffer_load_dwordx4 v8, s[16:19], 0 offen offset:256 lds
s_add_u32 m0, s47, 19328
s_nop 0
buffer_load_dwordx4 v8, s[16:19], 0 offen offset:1152 lds
s_add_u32 m0, s47, 24192
s_nop 0
buffer_load_dwordx4 v8, s[16:19], 0 offen offset:384 lds
s_waitcnt lgkmcnt(0)
s_mov_b64 vcc, 0
s_branch L_B
L_A:
s_add_u32 m0, s47, 48384
s_nop 0
buffer_load_dwordx4 v8, s[16:19], 0 offen offset:768 lds
s_add_u32 m0, s47, 152576
s_nop 0
buffer_load_dwordx4 v253, s[36:39], s47 offen lds
s_waitcnt lgkmcnt(0)
s_waitcnt vmcnt(12)
ds_read_b128 v[116:119], v11 offset:0
ds_read_b128 a[184:187], v11 offset:0
s_add_u32 m0, s48, 53248
s_nop 0
buffer_load_dwordx4 v254, s[24:27], s44 offen lds
s_waitcnt vmcnt(12)
ds_read_b128 v[124:127], v10 offset:4096
ds_read_b128 a[188:191], v10 offset:4096
s_add_u32 m0, s47, 126976
s_nop 0
buffer_load_dwordx4 v254, s[24:27], s51 offen lds
s_waitcnt lgkmcnt(3)
v_lshlrev_b32 v112, 16, v116
v_and_b32 v116, s54, v116
v_lshlrev_b32 v113, 16, v117
v_and_b32 v117, s54, v117
v_lshlrev_b32 v114, 16, v118
v_and_b32 v118, s54, v118
v_lshlrev_b32 v115, 16, v119
v_and_b32 v119, s54, v119
s_waitcnt vmcnt(12)
ds_read_b128 v[132:135], v11 offset:8192
ds_read_b128 a[192:195], v11 offset:8192
s_add_u32 m0, s48, 55296
s_nop 0
buffer_load_dwordx4 v254, s[24:27], s45 offen lds
s_waitcnt lgkmcnt(3)
v_lshlrev_b32 v120, 16, v124
v_and_b32 v124, s54, v124
v_lshlrev_b32 v121, 16, v125
v_and_b32 v125, s54, v125
v_lshlrev_b32 v122, 16, v126
v_and_b32 v126, s54, v126
v_lshlrev_b32 v123, 16, v127
v_and_b32 v127, s54, v127
s_waitcnt vmcnt(12)
ds_read_b128 v[140:143], v10 offset:12288
ds_read_b128 a[196:199], v10 offset:12288
s_add_u32 m0, s48, 57344
s_nop 0
buffer_load_dwordx4 v254, s[24:27], s46 offen lds
s_waitcnt lgkmcnt(3)
v_lshlrev_b32 v128, 16, v132
v_and_b32 v132, s54, v132
v_lshlrev_b32 v129, 16, v133
v_and_b32 v133, s54, v133
v_lshlrev_b32 v130, 16, v134
v_and_b32 v134, s54, v134
v_lshlrev_b32 v131, 16, v135
v_and_b32 v135, s54, v135
s_waitcnt vmcnt(12)
ds_read_b128 v[148:151], v11 offset:16384
ds_read_b128 a[200:203], v11 offset:16384
s_add_u32 m0, s49, 131072
s_nop 0
buffer_load_dwordx4 v254, s[24:27], s52 offen lds
s_waitcnt lgkmcnt(3)
v_lshlrev_b32 v136, 16, v140
v_and_b32 v140, s54, v140
v_lshlrev_b32 v137, 16, v141
v_and_b32 v141, s54, v141
v_lshlrev_b32 v138, 16, v142
v_and_b32 v142, s54, v142
v_lshlrev_b32 v139, 16, v143
v_and_b32 v143, s54, v143
s_waitcnt vmcnt(12)
ds_read_b128 v[156:159], v10 offset:20480
ds_read_b128 a[204:207], v10 offset:20480
s_add_u32 m0, s50, 139264
s_nop 0
buffer_load_dwordx4 v253, s[24:27], s53 offen lds
buffer_load_dwordx4 v253, s[24:27], s53 offen offset:640 lds
s_waitcnt lgkmcnt(3)
v_lshlrev_b32 v144, 16, v148
v_and_b32 v148, s54, v148
v_lshlrev_b32 v145, 16, v149
v_and_b32 v149, s54, v149
v_lshlrev_b32 v146, 16, v150
v_and_b32 v150, s54, v150
v_lshlrev_b32 v147, 16, v151
v_and_b32 v151, s54, v151
s_waitcnt vmcnt(13)
ds_read_b128 v[164:167], v11 offset:24576
ds_read_b128 a[208:211], v11 offset:24576
s_add_u32 m0, s48, 65408
s_nop 0
buffer_load_dwordx4 v254, s[24:27], s44 offen offset:128 lds
s_waitcnt lgkmcnt(3)
v_lshlrev_b32 v152, 16, v156
v_and_b32 v156, s54, v156
v_lshlrev_b32 v153, 16, v157
v_and_b32 v157, s54, v157
v_lshlrev_b32 v154, 16, v158
v_and_b32 v158, s54, v158
v_lshlrev_b32 v155, 16, v159
v_and_b32 v159, s54, v159
s_waitcnt vmcnt(13)
ds_read_b128 v[172:175], v10 offset:28672
ds_read_b128 a[212:215], v10 offset:28672
s_add_u32 m0, s48, 67456
s_nop 0
buffer_load_dwordx4 v254, s[24:27], s45 offen offset:128 lds
s_waitcnt lgkmcnt(3)
v_lshlrev_b32 v160, 16, v164
v_and_b32 v164, s54, v164
v_lshlrev_b32 v161, 16, v165
v_and_b32 v165, s54, v165
v_lshlrev_b32 v162, 16, v166
v_and_b32 v166, s54, v166
v_lshlrev_b32 v163, 16, v167
v_and_b32 v167, s54, v167
s_waitcnt vmcnt(13)
ds_read_b128 v[180:183], v11 offset:32768
ds_read_b128 a[216:219], v11 offset:32768
s_add_u32 m0, s48, 69504
s_nop 0
buffer_load_dwordx4 v254, s[24:27], s46 offen offset:128 lds
s_waitcnt lgkmcnt(3)
v_lshlrev_b32 v168, 16, v172
v_and_b32 v172, s54, v172
v_lshlrev_b32 v169, 16, v173
v_and_b32 v173, s54, v173
v_lshlrev_b32 v170, 16, v174
v_and_b32 v174, s54, v174
v_lshlrev_b32 v171, 16, v175
v_and_b32 v175, s54, v175
s_waitcnt vmcnt(13)
ds_read_b128 v[188:191], v10 offset:36864
ds_read_b128 a[220:223], v10 offset:36864
s_add_u32 m0, s48, 77568
s_nop 0
buffer_load_dwordx4 v254, s[24:27], s44 offen offset:256 lds
s_waitcnt lgkmcnt(3)
v_lshlrev_b32 v176, 16, v180
v_and_b32 v180, s54, v180
v_lshlrev_b32 v177, 16, v181
v_and_b32 v181, s54, v181
v_lshlrev_b32 v178, 16, v182
v_and_b32 v182, s54, v182
v_lshlrev_b32 v179, 16, v183
v_and_b32 v183, s54, v183
s_waitcnt vmcnt(13)
ds_read_b128 v[196:199], v11 offset:40960
ds_read_b128 a[224:227], v11 offset:40960
s_add_u32 m0, s48, 79616
s_nop 0
buffer_load_dwordx4 v254, s[24:27], s45 offen offset:256 lds
s_waitcnt lgkmcnt(3)
v_lshlrev_b32 v184, 16, v188
v_and_b32 v188, s54, v188
v_lshlrev_b32 v185, 16, v189
v_and_b32 v189, s54, v189
v_lshlrev_b32 v186, 16, v190
v_and_b32 v190, s54, v190
v_lshlrev_b32 v187, 16, v191
v_and_b32 v191, s54, v191
s_waitcnt vmcnt(13)
ds_read_b128 v[108:111], v9 offset:0
ds_read_b128 a[180:183], v9 offset:0
s_add_u32 m0, s48, 81664
s_nop 0
buffer_load_dwordx4 v254, s[24:27], s46 offen offset:256 lds
s_waitcnt lgkmcnt(3)
v_lshlrev_b32 v192, 16, v196
v_and_b32 v196, s54, v196
v_lshlrev_b32 v193, 16, v197
v_and_b32 v197, s54, v197
v_lshlrev_b32 v194, 16, v198
v_and_b32 v198, s54, v198
v_lshlrev_b32 v195, 16, v199
v_and_b32 v199, s54, v199
ds_read_b128 v[204:207], v10 offset:45056
ds_read_b128 a[228:231], v10 offset:45056
s_add_u32 m0, s48, 89728
s_nop 0
buffer_load_dwordx4 v254, s[24:27], s44 offen offset:384 lds
s_waitcnt lgkmcnt(3)
v_lshlrev_b32 v104, 16, v108
v_and_b32 v108, s54, v108
v_lshlrev_b32 v105, 16, v109
v_and_b32 v109, s54, v109
v_lshlrev_b32 v106, 16, v110
v_and_b32 v110, s54, v110
v_lshlrev_b32 v107, 16, v111
v_and_b32 v111, s54, v111
s_waitcnt lgkmcnt(1)
v_lshlrev_b32 v200, 16, v204
v_and_b32 v204, s54, v204
v_lshlrev_b32 v201, 16, v205
v_and_b32 v205, s54, v205
v_lshlrev_b32 v202, 16, v206
v_and_b32 v206, s54, v206
v_lshlrev_b32 v203, 16, v207
v_and_b32 v207, s54, v207
s_mov_b64 vcc, 0
s_waitcnt vmcnt(7)
s_barrier
s_add_u32 m0, s48, 91776
ds_read_b128 a[0:3], v20 offset:0
ds_read_b128 a[4:7], v251 offset:49152
ds_read_b128 a[8:11], v20 offset:2048
ds_read_b128 a[12:15], v251 offset:51200
ds_read_b128 a[16:19], v20 offset:4096
ds_read_b128 a[20:23], v251 offset:53248
ds_read_b128 a[24:27], v252 offset:0
ds_read_b128 a[28:31], v21 offset:0
ds_read_b128 a[32:35], v20 offset:6144
ds_read_b128 a[36:39], v21 offset:2048
buffer_load_dwordx4 v254, s[24:27], s45 offen offset:384 lds
s_waitcnt lgkmcnt(9)
v_mfma_f32_16x16x32_bf16 v[208:211], a[0:3], a[180:183], 0
s_waitcnt lgkmcnt(8)
s_add_u32 m0, s48, 93824
ds_read_b128 a[40:43], v20 offset:8192
v_mfma_f32_16x16x32_bf16 v[212:215], a[4:7], a[180:183], 0
s_waitcnt lgkmcnt(8)
ds_read_b128 a[44:47], v21 offset:4096
v_mfma_f32_16x16x32_bf16 v[216:219], a[8:11], a[180:183], 0
s_waitcnt vmcnt(5) lgkmcnt(7)
ds_read_b128 a[48:51], v20 offset:10240
buffer_load_dwordx4 v254, s[24:27], s46 offen offset:384 lds
v_mfma_f32_16x16x32_bf16 v[220:223], a[12:15], a[180:183], 0
s_barrier
s_add_u32 m0, s48, 101888
ds_read_b128 a[52:55], v252 offset:64
v_mfma_f32_16x16x32_bf16 v[224:227], a[16:19], a[180:183], 0
s_waitcnt lgkmcnt(8)
ds_read_b128 a[56:59], v20 offset:12288
v_mfma_f32_16x16x32_bf16 v[228:231], a[20:23], a[180:183], 0
s_waitcnt lgkmcnt(5)
ds_read_b128 a[60:63], v21 offset:6144
buffer_load_dwordx4 v254, s[24:27], s44 offen offset:512 lds
v_mfma_f32_16x16x32_bf16 v[232:235], a[24:27], a[180:183], 0
s_add_u32 m0, s48, 103936
ds_read_b128 a[64:67], v20 offset:14336
v_mfma_f32_16x16x32_bf16 v[208:211], a[28:31], a[184:187], v[208:211]
ds_read_b128 a[68:71], v21 offset:8192
v_mfma_f32_16x16x32_bf16 v[212:215], a[32:35], a[184:187], v[212:215]
ds_read_b128 a[0:3], v20 offset:16384
buffer_load_dwordx4 v254, s[24:27], s45 offen offset:512 lds
v_mfma_f32_16x16x32_bf16 v[216:219], a[36:39], a[184:187], v[216:219]
s_waitcnt lgkmcnt(5)
s_add_u32 m0, s48, 105984
ds_read_b128 a[4:7], v21 offset:10240
v_mfma_f32_16x16x32_bf16 v[220:223], a[40:43], a[184:187], v[220:223]
ds_read_b128 a[8:11], v252 offset:128
v_mfma_f32_16x16x32_bf16 v[224:227], a[44:47], a[184:187], v[224:227]
ds_read_b128 a[12:15], v21 offset:12288
buffer_load_dwordx4 v254, s[24:27], s46 offen offset:512 lds
v_mfma_f32_16x16x32_bf16 v[228:231], a[48:51], a[184:187], v[228:231]
s_add_u32 m0, s48, 114048
ds_read_b128 a[16:19], v20 offset:18432
v_mfma_f32_16x16x32_bf16 v[232:235], a[52:55], a[184:187], v[232:235]
s_waitcnt lgkmcnt(5)
ds_read_b128 a[20:23], v21 offset:14336
v_mfma_f32_16x16x32_bf16 v[208:211], a[56:59], a[188:191], v[208:211]
ds_read_b128 a[24:27], v20 offset:20480
buffer_load_dwordx4 v254, s[24:27], s44 offen offset:640 lds
v_mfma_f32_16x16x32_bf16 v[212:215], a[60:63], a[188:191], v[212:215]
s_add_u32 m0, s48, 116096
ds_read_b128 a[28:31], v21 offset:16384
v_mfma_f32_16x16x32_bf16 v[216:219], a[64:67], a[188:191], v[216:219]
s_waitcnt vmcnt(7) lgkmcnt(5)
ds_read_b128 a[32:35], v20 offset:22528
v_mfma_f32_16x16x32_bf16 v[220:223], a[68:71], a[188:191], v[220:223]
s_barrier
ds_read_b128 a[36:39], v252 offset:192
buffer_load_dwordx4 v254, s[24:27], s45 offen offset:640 lds
v_mfma_f32_16x16x32_bf16 v[224:227], a[0:3], a[188:191], v[224:227]
s_add_u32 m0, s48, 118144
ds_read_b128 a[40:43], v250 offset:0
v_mfma_f32_16x16x32_bf16 v[228:231], a[4:7], a[188:191], v[228:231]
ds_read_b128 a[44:47], v21 offset:18432
v_mfma_f32_16x16x32_bf16 v[232:235], a[8:11], a[188:191], v[232:235]
s_waitcnt lgkmcnt(5)
ds_read_b128 a[48:51], v250 offset:2048
buffer_load_dwordx4 v254, s[24:27], s46 offen offset:640 lds
v_mfma_f32_16x16x32_bf16 v[208:211], a[12:15], a[192:195], v[208:211]
s_mov_b32 m0, s47
ds_read_b128 a[52:55], v21 offset:20480
v_mfma_f32_16x16x32_bf16 v[212:215], a[16:19], a[192:195], v[212:215]
L_pad1:
s_cbranch_vccnz L_rT
ds_read_b128 a[56:59], v250 offset:4096
v_mfma_f32_16x16x32_bf16 v[216:219], a[20:23], a[192:195], v[216:219]
ds_read_b128 a[60:63], v21 offset:22528
buffer_load_dwordx4 v253, s[28:31], m0 offen lds
v_mfma_f32_16x16x32_bf16 v[220:223], a[24:27], a[192:195], v[220:223]
s_waitcnt lgkmcnt(5)
s_add_u32 m0, s47, 4096
ds_read_b128 a[64:67], v252 offset:256
v_mfma_f32_16x16x32_bf16 v[224:227], a[28:31], a[192:195], v[224:227]
ds_read_b128 a[68:71], v251 offset:0
v_mfma_f32_16x16x32_bf16 v[228:231], a[32:35], a[192:195], v[228:231]
ds_read_b128 a[0:3], v250 offset:6144
buffer_load_dwordx4 v253, s[28:31], m0 offen lds
v_mfma_f32_16x16x32_bf16 v[232:235], a[36:39], a[192:195], v[232:235]
s_add_u32 m0, s47, 8192
ds_read_b128 a[4:7], v251 offset:2048
v_mfma_f32_16x16x32_bf16 v[208:211], a[40:43], a[196:199], v[208:211]
s_waitcnt lgkmcnt(5)
ds_read_b128 a[8:11], v250 offset:8192
v_mfma_f32_16x16x32_bf16 v[212:215], a[44:47], a[196:199], v[212:215]
ds_read_b128 a[12:15], v251 offset:4096
buffer_load_dwordx4 v253, s[28:31], m0 offen lds
v_mfma_f32_16x16x32_bf16 v[216:219], a[48:51], a[196:199], v[216:219]
s_waitcnt vmcnt(9) lgkmcnt(5)
s_add_u32 m0, s47, 12288
ds_read_b128 a[16:19], v250 offset:10240
v_mfma_f32_16x16x32_bf16 v[220:223], a[52:55], a[196:199], v[220:223]
s_barrier
ds_read_b128 a[20:23], v252 offset:320
v_mfma_f32_16x16x32_bf16 v[224:227], a[56:59], a[196:199], v[224:227]
ds_read_b128 a[24:27], v250 offset:12288
buffer_load_dwordx4 v253, s[28:31], m0 offen lds
v_mfma_f32_16x16x32_bf16 v[228:231], a[60:63], a[196:199], v[228:231]
s_add_u32 m0, s47, 16384
ds_read_b128 a[28:31], v251 offset:6144
v_mfma_f32_16x16x32_bf16 v[232:235], a[64:67], a[196:199], v[232:235]
s_waitcnt lgkmcnt(5)
ds_read_b128 a[32:35], v250 offset:14336
v_mfma_f32_16x16x32_bf16 v[208:211], a[68:71], a[200:203], v[208:211]
ds_read_b128 a[36:39], v251 offset:8192
buffer_load_dwordx4 v253, s[28:31], m0 offen lds
v_mfma_f32_16x16x32_bf16 v[212:215], a[0:3], a[200:203], v[212:215]
s_add_u32 s51, s51, 86528
ds_read_b128 a[40:43], v250 offset:16384
v_mfma_f32_16x16x32_bf16 v[216:219], a[4:7], a[200:203], v[216:219]
s_add_u32 m0, s47, 133120
ds_read_b128 a[44:47], v251 offset:10240
v_mfma_f32_16x16x32_bf16 v[220:223], a[8:11], a[200:203], v[220:223]
s_waitcnt lgkmcnt(5)
ds_read_b128 a[48:51], v252 offset:384
buffer_load_dwordx4 v254, s[24:27], s51 offen lds
v_mfma_f32_16x16x32_bf16 v[224:227], a[12:15], a[200:203], v[224:227]
s_add_u32 s52, s52, 86528
ds_read_b128 a[52:55], v251 offset:12288
v_mfma_f32_16x16x32_bf16 v[228:231], a[16:19], a[200:203], v[228:231]
s_add_u32 m0, s49, 137216
ds_read_b128 a[56:59], v250 offset:18432
v_mfma_f32_16x16x32_bf16 v[232:235], a[20:23], a[200:203], v[232:235]
ds_read_b128 a[60:63], v251 offset:14336
buffer_load_dwordx4 v254, s[24:27], s52 offen lds
v_mfma_f32_16x16x32_bf16 v[208:211], a[24:27], a[204:207], v[208:211]
s_waitcnt lgkmcnt(5)
s_add_u32 s53, s53, 86528
ds_read_b128 a[64:67], v250 offset:20480
v_mfma_f32_16x16x32_bf16 v[212:215], a[28:31], a[204:207], v[212:215]
s_add_u32 m0, s50, 145920
ds_read_b128 a[68:71], v251 offset:16384
v_mfma_f32_16x16x32_bf16 v[216:219], a[32:35], a[204:207], v[216:219]
s_waitcnt vmcnt(10) lgkmcnt(5)
ds_read_b128 a[0:3], v250 offset:22528
buffer_load_dwordx4 v253, s[24:27], s53 offen lds
v_mfma_f32_16x16x32_bf16 v[220:223], a[36:39], a[204:207], v[220:223]
s_barrier
ds_read_b128 a[4:7], v252 offset:448
v_mfma_f32_16x16x32_bf16 v[224:227], a[40:43], a[204:207], v[224:227]
ds_read_b128 a[8:11], v250 offset:24576
v_mfma_f32_16x16x32_bf16 v[228:231], a[44:47], a[204:207], v[228:231]
ds_read_b128 a[12:15], v251 offset:18432
buffer_load_dwordx4 v253, s[24:27], s53 offen offset:640 lds
v_mfma_f32_16x16x32_bf16 v[232:235], a[48:51], a[204:207], v[232:235]
s_waitcnt lgkmcnt(5)
s_mov_b32 s44, 86528
ds_read_b128 a[16:19], v250 offset:26624
v_mfma_f32_16x16x32_bf16 v[208:211], a[52:55], a[208:211], v[208:211]
s_add_u32 m0, s48, 77824
ds_read_b128 a[20:23], v251 offset:20480
v_mfma_f32_16x16x32_bf16 v[212:215], a[56:59], a[208:211], v[212:215]
ds_read_b128 a[24:27], v250 offset:28672
buffer_load_dwordx4 v254, s[24:27], s44 offen lds
v_mfma_f32_16x16x32_bf16 v[216:219], a[60:63], a[208:211], v[216:219]
s_mov_b32 s45, 113152
ds_read_b128 a[28:31], v251 offset:22528
ds_read2_b32 a[74:75], v243 offset0:0 offset1:0
v_mfma_f32_16x16x32_bf16 v[220:223], a[64:67], a[208:211], v[220:223]
s_waitcnt lgkmcnt(6)
s_add_u32 m0, s48, 79872
ds_read_b128 a[32:35], v252 offset:512
v_mfma_f32_16x16x32_bf16 v[224:227], a[68:71], a[208:211], v[224:227]
ds_read_b128 a[36:39], v251 offset:24576
buffer_load_dwordx4 v254, s[24:27], s45 offen lds
v_mfma_f32_16x16x32_bf16 v[228:231], a[0:3], a[208:211], v[228:231]
s_mov_b32 s46, 139776
ds_read_b128 a[40:43], v250 offset:30720
ds_read2_b32 a[80:81], v243 offset0:16 offset1:16
v_mfma_f32_16x16x32_bf16 v[232:235], a[4:7], a[208:211], v[232:235]
s_add_u32 m0, s48, 81920
ds_read_b128 a[44:47], v251 offset:26624
v_mfma_f32_16x16x32_bf16 v[208:211], a[8:11], a[212:215], v[208:211]
s_waitcnt lgkmcnt(7)
ds_read_b128 a[48:51], v250 offset:32768
buffer_load_dwordx4 v254, s[24:27], s46 offen lds
v_mfma_f32_16x16x32_bf16 v[212:215], a[12:15], a[212:215], v[212:215]
s_add_u32 m0, s47, 20480
ds_read_b128 a[52:55], v251 offset:28672
ds_read2_b32 a[86:87], v243 offset0:32 offset1:32
v_mfma_f32_16x16x32_bf16 v[216:219], a[16:19], a[212:215], v[216:219]
s_waitcnt vmcnt(12) lgkmcnt(7)
ds_read_b128 a[56:59], v250 offset:34816
v_mfma_f32_16x16x32_bf16 v[220:223], a[20:23], a[212:215], v[220:223]
s_barrier
ds_read_b128 a[60:63], v252 offset:576
buffer_load_dwordx4 v253, s[28:31], m0 offen lds
v_mfma_f32_16x16x32_bf16 v[224:227], a[24:27], a[212:215], v[224:227]
s_add_u32 m0, s47, 24576
ds_read_b128 a[64:67], v250 offset:36864
ds_read2_b32 a[92:93], v243 offset0:48 offset1:48
v_mfma_f32_16x16x32_bf16 v[228:231], a[28:31], a[212:215], v[228:231]
ds_read_b128 a[68:71], v251 offset:30720
v_mfma_f32_16x16x32_bf16 v[232:235], a[32:35], a[212:215], v[232:235]
s_waitcnt lgkmcnt(7)
ds_read_b128 a[0:3], v250 offset:38912
buffer_load_dwordx4 v253, s[28:31], m0 offen lds
v_mfma_f32_16x16x32_bf16 v[208:211], a[36:39], a[216:219], v[208:211]
s_add_u32 m0, s47, 28672
ds_read_b128 a[4:7], v251 offset:32768
ds_read2_b32 a[98:99], v243 offset0:64 offset1:64
v_mfma_f32_16x16x32_bf16 v[212:215], a[40:43], a[216:219], v[212:215]
ds_read_b128 a[8:11], v250 offset:40960
v_mfma_f32_16x16x32_bf16 v[216:219], a[44:47], a[216:219], v[216:219]
ds_read_b128 a[12:15], v251 offset:34816
buffer_load_dwordx4 v253, s[28:31], m0 offen lds
v_mfma_f32_16x16x32_bf16 v[220:223], a[48:51], a[216:219], v[220:223]
s_waitcnt lgkmcnt(6)
s_add_u32 m0, s47, 32768
ds_read_b128 a[16:19], v252 offset:640
ds_read2_b32 a[104:105], v243 offset0:80 offset1:80
v_mfma_f32_16x16x32_bf16 v[224:227], a[52:55], a[216:219], v[224:227]
ds_read_b128 a[20:23], v251 offset:36864
v_mfma_f32_16x16x32_bf16 v[228:231], a[56:59], a[216:219], v[228:231]
ds_read_b128 a[24:27], v250 offset:43008
buffer_load_dwordx4 v253, s[28:31], m0 offen lds
v_mfma_f32_16x16x32_bf16 v[232:235], a[60:63], a[216:219], v[232:235]
s_add_u32 m0, s48, 89984
ds_read_b128 a[28:31], v251 offset:38912
ds_read2_b32 a[110:111], v243 offset0:96 offset1:96
v_mfma_f32_16x16x32_bf16 v[208:211], a[64:67], a[220:223], v[208:211]
s_waitcnt lgkmcnt(7)
ds_read_b128 a[32:35], v250 offset:45056
v_mfma_f32_16x16x32_bf16 v[212:215], a[68:71], a[220:223], v[212:215]
ds_read_b128 a[36:39], v251 offset:40960
buffer_load_dwordx4 v254, s[24:27], s44 offen offset:128 lds
v_mfma_f32_16x16x32_bf16 v[216:219], a[0:3], a[220:223], v[216:219]
s_waitcnt vmcnt(13) lgkmcnt(6)
s_add_u32 m0, s48, 92032
ds_read_b128 a[40:43], v250 offset:47104
ds_read2_b32 a[116:117], v243 offset0:112 offset1:112
v_mfma_f32_16x16x32_bf16 v[220:223], a[4:7], a[220:223], v[220:223]
s_barrier
ds_read_b128 a[44:47], v252 offset:704
v_mfma_f32_16x16x32_bf16 v[224:227], a[8:11], a[220:223], v[224:227]
ds_read_b128 a[48:51], v250 offset:49152
buffer_load_dwordx4 v254, s[24:27], s45 offen offset:128 lds
v_mfma_f32_16x16x32_bf16 v[228:231], a[12:15], a[220:223], v[228:231]
s_add_u32 m0, s48, 94080
ds_read_b128 a[52:55], v251 offset:43008
ds_read2_b32 a[122:123], v243 offset0:128 offset1:128
v_mfma_f32_16x16x32_bf16 v[232:235], a[16:19], a[220:223], v[232:235]
s_waitcnt lgkmcnt(7)
ds_read_b128 a[56:59], v250 offset:51200
v_mfma_f32_16x16x32_bf16 v[208:211], a[20:23], a[224:227], v[208:211]
ds_read_b128 a[60:63], v251 offset:45056
buffer_load_dwordx4 v254, s[24:27], s46 offen offset:128 lds
v_mfma_f32_16x16x32_bf16 v[212:215], a[24:27], a[224:227], v[212:215]
s_add_u32 m0, s47, 36864
ds_read_b128 a[64:67], v250 offset:53248
ds_read2_b32 a[128:129], v243 offset0:144 offset1:144
v_mfma_f32_16x16x32_bf16 v[216:219], a[28:31], a[224:227], v[216:219]
ds_read_b128 a[68:71], v251 offset:47104
v_mfma_f32_16x16x32_bf16 v[220:223], a[32:35], a[224:227], v[220:223]
s_waitcnt lgkmcnt(7)
ds_read_b128 a[0:3], v252 offset:768
buffer_load_dwordx4 v253, s[28:31], m0 offen lds
v_mfma_f32_16x16x32_bf16 v[224:227], a[36:39], a[224:227], v[224:227]
s_add_u32 m0, s47, 40960
ds_read_b128 a[4:7], v248 offset:0
ds_read2_b32 a[134:135], v243 offset0:160 offset1:160
v_mfma_f32_16x16x32_bf16 v[228:231], a[40:43], a[224:227], v[228:231]
ds_read_b128 a[8:11], v248 offset:208
v_mfma_f32_16x16x32_bf16 v[232:235], a[44:47], a[224:227], v[232:235]
ds_read_b128 a[12:15], v248 offset:6656
buffer_load_dwordx4 v253, s[28:31], m0 offen lds
v_mfma_f32_16x16x32_bf16 v[208:211], a[48:51], a[228:231], v[208:211]
s_waitcnt lgkmcnt(6)
s_add_u32 m0, s47, 45056
ds_read_b128 a[16:19], v248 offset:6864
ds_read2_b32 a[140:141], v243 offset0:176 offset1:176
v_mfma_f32_16x16x32_bf16 v[212:215], a[52:55], a[228:231], v[212:215]
ds_read_b128 a[20:23], v248 offset:64
v_mfma_f32_16x16x32_bf16 v[216:219], a[56:59], a[228:231], v[216:219]
ds_read_b128 a[24:27], v248 offset:272
buffer_load_dwordx4 v253, s[28:31], m0 offen lds
v_mfma_f32_16x16x32_bf16 v[220:223], a[60:63], a[228:231], v[220:223]
s_add_u32 m0, s48, 102144
ds_read_b128 a[28:31], v248 offset:6720
ds_read2_b32 a[146:147], v243 offset0:192 offset1:192
v_mfma_f32_16x16x32_bf16 v[224:227], a[64:67], a[228:231], v[224:227]
s_waitcnt lgkmcnt(7)
ds_read_b128 a[32:35], v248 offset:6928
v_cvt_pk_bf16_f32 v208, v208, v212
v_cvt_pk_bf16_f32 v209, v209, v213
v_cvt_pk_bf16_f32 v210, v210, v214
v_cvt_pk_bf16_f32 v211, v211, v215
v_accvgpr_write_b32 a150, v208
v_accvgpr_write_b32 a151, v209
v_mfma_f32_16x16x32_bf16 v[228:231], a[68:71], a[228:231], v[228:231]
ds_read_b128 a[36:39], v248 offset:128
buffer_load_dwordx4 v254, s[24:27], s44 offen offset:256 lds
v_accvgpr_write_b32 a152, v210
v_accvgpr_write_b32 a153, v211
v_mfma_f32_16x16x32_bf16 v[232:235], a[0:3], a[228:231], v[232:235]
s_waitcnt vmcnt(11) lgkmcnt(6)
s_add_u32 m0, s48, 104192
ds_read_b128 a[40:43], v248 offset:336
v_cvt_pk_bf16_f32 v216, v216, v220
v_cvt_pk_bf16_f32 v217, v217, v221
v_mfma_f32_16x16x32_bf16 v[0:3], a[4:7], a[150:153], 1.0
s_barrier
ds_read_b128 a[44:47], v248 offset:6784
buffer_load_dwordx4 v254, s[24:27], s45 offen offset:256 lds
v_cvt_pk_bf16_f32 v218, v218, v222
v_cvt_pk_bf16_f32 v219, v219, v223
v_mfma_f32_16x16x32_bf16 v[4:7], a[8:11], a[150:153], 1.0
s_add_u32 m0, s48, 106240
ds_read_b128 a[48:51], v248 offset:6992
v_accvgpr_write_b32 a154, v216
v_accvgpr_write_b32 a155, v217
v_mfma_f32_16x16x32_bf16 v[8:11], a[12:15], a[150:153], 1.0
ds_read_b64 a[72:73], v249 offset:0
buffer_load_dwordx4 v254, s[24:27], s46 offen offset:256 lds
v_accvgpr_write_b32 a156, v218
v_accvgpr_write_b32 a157, v219
v_mfma_f32_16x16x32_bf16 v[12:15], a[16:19], a[150:153], 1.0
s_waitcnt lgkmcnt(5)
ds_read_b64 a[76:77], v249 offset:208
v_cvt_pk_bf16_f32 v224, v224, v228
v_cvt_pk_bf16_f32 v225, v225, v229
v_mfma_f32_16x16x32_bf16 v[0:3], a[20:23], a[154:157], v[0:3]
s_add_u32 m0, s47, 49152
ds_read_b64 a[78:79], v249 offset:6656
buffer_load_dwordx4 v253, s[28:31], m0 offen lds
v_cvt_pk_bf16_f32 v226, v226, v230
v_cvt_pk_bf16_f32 v227, v227, v231
v_mfma_f32_16x16x32_bf16 v[4:7], a[24:27], a[154:157], v[4:7]
s_add_u32 m0, s48, 114304
ds_read_b64 a[82:83], v249 offset:6864
v_accvgpr_write_b32 a158, v224
v_accvgpr_write_b32 a159, v225
v_mfma_f32_16x16x32_bf16 v[8:11], a[28:31], a[154:157], v[8:11]
ds_read_b128 a[52:55], v248 offset:13312
buffer_load_dwordx4 v254, s[24:27], s44 offen offset:384 lds
v_accvgpr_write_b32 a160, v226
v_accvgpr_write_b32 a161, v227
v_mfma_f32_16x16x32_bf16 v[12:15], a[32:35], a[154:157], v[12:15]
s_waitcnt lgkmcnt(5)
ds_read_b128 a[56:59], v248 offset:13520
v_cvt_pk_bf16_f32 v232, v232, v233
v_mfma_f32_16x16x32_bf16 v[0:3], a[36:39], a[158:161], v[0:3]
s_add_u32 m0, s48, 116352
ds_read_b128 a[60:63], v248 offset:13376
buffer_load_dwordx4 v254, s[24:27], s45 offen offset:384 lds
v_cvt_pk_bf16_f32 v234, v234, v235
v_mfma_f32_16x16x32_bf16 v[4:7], a[40:43], a[158:161], v[4:7]
s_add_u32 m0, s48, 118400
ds_read_b128 a[64:67], v248 offset:13584
ds_read_b128 a[68:71], v248 offset:13440
v_cndmask_b32_e64 v232, 0, v232, s[56:57]
v_cndmask_b32_e64 v234, 0, v234, s[56:57]
v_mfma_f32_16x16x32_bf16 v[8:11], a[44:47], a[158:161], v[8:11]
ds_read_b128 a[0:3], v248 offset:13648
buffer_load_dwordx4 v254, s[24:27], s46 offen offset:384 lds
v_accvgpr_write_b32 a164, v232
v_accvgpr_write_b32 a165, v234
v_mfma_f32_16x16x32_bf16 v[12:15], a[48:51], a[158:161], v[12:15]
s_waitcnt lgkmcnt(6)
ds_read_b64 a[84:85], v249 offset:13312
v_mfma_f32_16x16x32_bf16 v[0:3], a[72:75], a[164:167], v[0:3]
s_add_u32 s51, s51, 86528
ds_read_b64 a[88:89], v249 offset:13520
ds_read_b128 a[4:7], v250 offset:0
v_mfma_f32_16x16x32_bf16 v[4:7], a[74:77], a[162:165], v[4:7]
s_add_u32 m0, s47, 126976
ds_read_b128 a[8:11], v251 offset:55296
buffer_load_dwordx4 v254, s[24:27], s51 offen lds
v_mfma_f32_16x16x32_bf16 v[8:11], a[78:81], a[164:167], v[8:11]
s_add_u32 s52, s52, 86528
ds_read_b128 a[12:15], v250 offset:2048
v_mfma_f32_16x16x32_bf16 v[12:15], a[80:83], a[162:165], v[12:15]
s_waitcnt vmcnt(14) lgkmcnt(6)
ds_read_b128 a[16:19], v251 offset:57344
ds_read_b128 a[20:23], v250 offset:4096
v_mfma_f32_16x16x32_bf16 v[16:19], a[52:55], a[150:153], 1.0
s_barrier
ds_read_b128 a[24:27], v251 offset:59392
v_mfma_f32_16x16x32_bf16 v[20:23], a[56:59], a[150:153], 1.0
s_add_u32 m0, s49, 131072
ds_read_b128 a[28:31], v252 offset:6656
buffer_load_dwordx4 v254, s[24:27], s52 offen lds
v_mul_f32 v244, v104, v0
v_mul_f32 v245, v108, v4
v_mfma_f32_16x16x32_bf16 v[16:19], a[60:63], a[154:157], v[16:19]
s_add_u32 s28, s28, 53248
s_addc_u32 s29, s29, 0
ds_read_b128 a[32:35], v248 offset:19968
ds_read_b128 a[36:39], v248 offset:20176
v_cvt_pk_bf16_f32 v236, v244, v245
v_mul_f32 v246, v105, v1
v_mfma_f32_16x16x32_bf16 v[20:23], a[64:67], a[154:157], v[20:23]
s_mov_b32 m0, s47
ds_read_b128 a[40:43], v248 offset:20032
buffer_load_dwordx4 v253, s[28:31], m0 offen lds
v_mul_f32 v247, v109, v5
v_cvt_pk_bf16_f32 v237, v246, v247
v_mfma_f32_16x16x32_bf16 v[16:19], a[68:71], a[158:161], v[16:19]
s_waitcnt lgkmcnt(7)
ds_read_b128 a[44:47], v248 offset:20240
v_mul_f32 v244, v106, v2
v_mul_f32 v245, v110, v6
v_mfma_f32_16x16x32_bf16 v[20:23], a[0:3], a[158:161], v[20:23]
s_add_u32 m0, s47, 4096
ds_read_b128 a[48:51], v248 offset:20096
ds_read_b128 a[52:55], v248 offset:20304
buffer_load_dwordx4 v253, s[28:31], m0 offen lds
v_cvt_pk_bf16_f32 v238, v244, v245
v_mul_f32 v246, v107, v3
v_mfma_f32_16x16x32_bf16 v[16:19], a[84:87], a[164:167], v[16:19]
s_add_u32 m0, s47, 8192
ds_read_b64 a[90:91], v249 offset:19968
v_mul_f32 v247, v111, v7
v_cvt_pk_bf16_f32 v239, v246, v247
v_mfma_f32_16x16x32_bf16 v[20:23], a[86:89], a[162:165], v[20:23]
ds_read_b64 a[94:95], v249 offset:20176
buffer_load_dwordx4 v253, s[28:31], m0 offen lds
v_mfma_f32_16x16x32_bf16 v[208:211], a[4:7], v[236:239], 0
s_add_u32 s53, s53, 86528
ds_read_b128 a[56:59], v251 offset:0
ds_read_b128 a[60:63], v250 offset:6144
v_mfma_f32_16x16x32_bf16 v[212:215], a[8:11], v[236:239], 0
s_add_u32 m0, s50, 139264
ds_read_b128 a[64:67], v251 offset:2048
buffer_load_dwordx4 v253, s[24:27], s53 offen lds
v_mfma_f32_16x16x32_bf16 v[216:219], a[12:15], v[236:239], 0
s_waitcnt lgkmcnt(7)
ds_read_b128 a[68:71], v250 offset:8192
v_mul_f32 v244, v112, v8
v_mfma_f32_16x16x32_bf16 v[220:223], a[16:19], v[236:239], 0
ds_read_b128 a[0:3], v251 offset:4096
buffer_load_dwordx4 v253, s[24:27], s53 offen offset:640 lds
v_mfma_f32_16x16x32_bf16 v[224:227], a[20:23], v[236:239], 0
ds_read_b128 a[4:7], v250 offset:10240
v_mul_f32 v245, v116, v12
v_mfma_f32_16x16x32_bf16 v[228:231], a[24:27], v[236:239], 0
ds_read_b128 a[8:11], v252 offset:6720
v_cvt_pk_bf16_f32 v240, v244, v245
v_mfma_f32_16x16x32_bf16 v[232:235], a[28:31], v[236:239], 0
ds_read_b128 a[12:15], v248 offset:26624
v_mul_f32 v246, v113, v9
v_mfma_f32_16x16x32_bf16 v[24:27], a[32:35], a[150:153], 1.0
s_waitcnt vmcnt(14) lgkmcnt(5)
ds_read_b128 a[16:19], v248 offset:26832
v_mul_f32 v247, v117, v13
v_mfma_f32_16x16x32_bf16 v[28:31], a[36:39], a[150:153], 1.0
s_barrier
ds_read_b128 a[20:23], v248 offset:26688
v_mfma_f32_16x16x32_bf16 v[24:27], a[40:43], a[154:157], v[24:27]
s_add_u32 m0, s47, 12288
ds_read_b128 a[24:27], v248 offset:26896
buffer_load_dwordx4 v253, s[28:31], m0 offen lds
v_mfma_f32_16x16x32_bf16 v[28:31], a[44:47], a[154:157], v[28:31]
s_add_u32 m0, s47, 16384
ds_read_b128 a[28:31], v248 offset:26752
v_cvt_pk_bf16_f32 v241, v246, v247
v_mfma_f32_16x16x32_bf16 v[24:27], a[48:51], a[158:161], v[24:27]
s_branch L_M
s_endpgm
s_endpgm
s_endpgm
s_endpgm
s_endpgm
s_endpgm
s_endpgm
s_endpgm
s_endpgm
s_endpgm
s_endpgm
s_endpgm
s_endpgm
s_endpgm
s_endpgm
s_endpgm
s_endpgm
s_endpgm
s_endpgm
s_endpgm
s_endpgm
s_endpgm
s_endpgm
s_endpgm
s_endpgm
s_endpgm
s_endpgm
s_endpgm
s_endpgm
s_endpgm
s_endpgm
s_endpgm
s_endpgm
s_endpgm
s_endpgm
s_endpgm
s_endpgm
s_endpgm
s_endpgm
s_endpgm
s_endpgm
s_endpgm
s_endpgm
s_endpgm
s_endpgm
s_endpgm
s_endpgm
s_endpgm
s_endpgm
s_endpgm
s_endpgm
s_endpgm
s_endpgm
s_endpgm
s_endpgm
s_endpgm
s_endpgm
s_endpgm
s_endpgm
s_endpgm
s_endpgm
s_endpgm
s_endpgm
s_endpgm
s_endpgm
s_endpgm
s_endpgm
s_endpgm
s_endpgm
s_endpgm
s_endpgm
s_endpgm
s_endpgm
s_endpgm
s_endpgm
s_endpgm
s_endpgm
s_endpgm
s_endpgm
s_endpgm
s_endpgm
s_endpgm
s_endpgm
s_endpgm
s_endpgm
s_endpgm
s_endpgm
s_endpgm
s_endpgm
s_endpgm
s_endpgm
s_endpgm
s_endpgm
s_endpgm
s_endpgm
s_endpgm
s_endpgm
s_endpgm
s_endpgm
s_endpgm
s_endpgm
s_endpgm
s_endpgm
s_endpgm
s_endpgm
s_endpgm
s_endpgm
s_endpgm
s_endpgm
s_endpgm
s_endpgm
s_endpgm
s_endpgm
s_endpgm
s_endpgm
s_endpgm
s_endpgm
s_endpgm
s_endpgm
s_endpgm
s_endpgm
s_endpgm
s_endpgm
s_endpgm
s_endpgm
s_endpgm
s_endpgm
s_endpgm
s_endpgm
s_endpgm
s_endpgm
s_endpgm
s_endpgm
s_endpgm
s_endpgm
s_endpgm
s_endpgm
s_endpgm
s_endpgm
s_endpgm
s_endpgm
s_endpgm
s_endpgm
s_endpgm
s_endpgm
s_endpgm
s_endpgm
s_endpgm
s_endpgm
s_endpgm
s_endpgm
s_endpgm
s_endpgm
s_endpgm
s_endpgm
s_endpgm
s_endpgm
s_endpgm
s_endpgm
s_endpgm
s_endpgm
s_endpgm
s_endpgm
s_endpgm
s_endpgm
s_endpgm
s_endpgm
s_endpgm
s_endpgm
s_endpgm
s_endpgm
s_endpgm
s_endpgm
s_endpgm
s_endpgm
s_endpgm
s_endpgm
s_endpgm
s_endpgm
s_endpgm
s_endpgm
s_endpgm
s_endpgm
s_endpgm
s_endpgm
s_endpgm
s_endpgm
s_endpgm
s_endpgm
s_endpgm
s_endpgm
s_endpgm
s_endpgm
s_endpgm
s_endpgm
s_endpgm
s_endpgm
s_endpgm
s_endpgm
s_endpgm
s_endpgm
s_endpgm
s_endpgm
s_endpgm
s_endpgm
s_endpgm
s_endpgm
s_endpgm
s_endpgm
s_endpgm
s_endpgm
s_endpgm
s_endpgm
s_endpgm
s_endpgm
s_endpgm
s_endpgm
s_endpgm
s_endpgm
s_endpgm
s_endpgm
s_endpgm
s_endpgm
s_endpgm
s_endpgm
s_endpgm
s_endpgm
s_endpgm
s_endpgm
s_endpgm
s_endpgm
s_endpgm
s_endpgm
s_endpgm
s_endpgm
s_endpgm
s_endpgm
s_endpgm
s_endpgm
s_endpgm
s_endpgm
s_endpgm
s_endpgm
s_endpgm
s_endpgm
s_endpgm
s_endpgm
s_endpgm
s_endpgm
s_endpgm
s_endpgm
s_endpgm
s_endpgm
s_endpgm
s_endpgm
s_endpgm
s_endpgm
s_endpgm
s_endpgm
s_endpgm
s_endpgm
s_endpgm
s_endpgm
s_endpgm
s_endpgm
s_endpgm
s_endpgm
s_endpgm
s_endpgm
s_endpgm
s_endpgm
s_endpgm
s_endpgm
s_endpgm
s_endpgm
s_endpgm
s_endpgm
s_endpgm
s_endpgm
s_endpgm
L_B:
s_cbranch_vccnz L_rT
s_waitcnt vmcnt(16)
s_barrier
s_add_u32 m0, s47, 27392
ds_read2_b32 a[146:147], v243 offset0:192 offset1:192
ds_read2_b32 a[140:141], v243 offset0:176 offset1:176
ds_read2_b32 a[134:135], v243 offset0:160 offset1:160
ds_read2_b32 a[128:129], v243 offset0:144 offset1:144
ds_read2_b32 a[122:123], v243 offset0:128 offset1:128
ds_read2_b32 a[116:117], v243 offset0:112 offset1:112
ds_read2_b32 a[110:111], v243 offset0:96 offset1:96
ds_read2_b32 a[104:105], v243 offset0:80 offset1:80
ds_read2_b32 a[98:99], v243 offset0:64 offset1:64
ds_read2_b32 a[92:93], v243 offset0:48 offset1:48
ds_read2_b32 a[86:87], v243 offset0:32 offset1:32
ds_read2_b32 a[80:81], v243 offset0:16 offset1:16
ds_read2_b32 a[74:75], v243 offset0:0 offset1:0
ds_read_b128 a[0:3], v20 offset:0
ds_read_b128 a[4:7], v251 offset:49152
ds_read_b128 a[8:11], v20 offset:2048
ds_read_b128 a[12:15], v251 offset:51200
ds_read_b128 a[16:19], v20 offset:4096
ds_read_b128 a[20:23], v251 offset:53248
ds_read_b128 a[24:27], v252 offset:0
ds_read_b128 a[28:31], v21 offset:0
ds_read_b128 a[32:35], v20 offset:6144
ds_read_b128 a[36:39], v21 offset:2048
buffer_load_dwordx4 v8, s[16:19], 0 offen offset:1280 lds
s_add_u32 m0, s47, 32256
s_nop 0
buffer_load_dwordx4 v8, s[16:19], 0 offen offset:512 lds
s_add_u32 m0, s47, 35456
s_nop 0
buffer_load_dwordx4 v8, s[16:19], 0 offen offset:1408 lds
s_add_u32 m0, s47, 40320
s_nop 0
buffer_load_dwordx4 v8, s[16:19], 0 offen offset:640 lds
s_add_u32 m0, s47, 43520
s_nop 0
buffer_load_dwordx4 v8, s[16:19], 0 offen offset:1536 lds
buffer_load_dword v17, v16, s[40:43], s14 offen
s_waitcnt vmcnt(12)
ds_read_b128 v[108:111], v9 offset:0
s_waitcnt lgkmcnt(0)
v_mfma_f32_16x16x32_bf16 v[208:211], a[0:3], v[108:111], 0
s_add_u32 s51, s51, 86528
ds_read_b128 a[40:43], v20 offset:8192
s_waitcnt vmcnt(11)
ds_read_b128 v[116:119], v11 offset:0
v_mfma_f32_16x16x32_bf16 v[212:215], a[4:7], v[108:111], 0
s_add_u32 m0, s47, 133120
ds_read_b128 a[44:47], v21 offset:4096
v_mfma_f32_16x16x32_bf16 v[216:219], a[8:11], v[108:111], 0
ds_read_b128 a[48:51], v20 offset:10240
v_mfma_f32_16x16x32_bf16 v[220:223], a[12:15], v[108:111], 0
ds_read_b128 a[52:55], v252 offset:64
v_mfma_f32_16x16x32_bf16 v[224:227], a[16:19], v[108:111], 0
ds_read_b128 a[56:59], v20 offset:12288
v_mfma_f32_16x16x32_bf16 v[228:231], a[20:23], v[108:111], 0
ds_read_b128 a[60:63], v21 offset:6144
v_mfma_f32_16x16x32_bf16 v[232:235], a[24:27], v[108:111], 0
s_waitcnt lgkmcnt(5)
ds_read_b128 a[64:67], v20 offset:14336
v_mfma_f32_16x16x32_bf16 v[208:211], a[28:31], v[116:119], v[208:211]
ds_read_b128 a[68:71], v21 offset:8192
s_waitcnt vmcnt(10)
ds_read_b128 v[124:127], v10 offset:4096
v_lshlrev_b32 v104, 16, v108
v_mfma_f32_16x16x32_bf16 v[212:215], a[32:35], v[116:119], v[212:215]
ds_read_b128 a[0:3], v20 offset:16384
v_and_b32 v108, s54, v108
v_lshlrev_b32 v105, 16, v109
v_mfma_f32_16x16x32_bf16 v[216:219], a[36:39], v[116:119], v[216:219]
ds_read_b128 a[4:7], v21 offset:10240
v_and_b32 v109, s54, v109
v_lshlrev_b32 v106, 16, v110
v_mfma_f32_16x16x32_bf16 v[220:223], a[40:43], v[116:119], v[220:223]
s_waitcnt lgkmcnt(6)
ds_read_b128 a[8:11], v252 offset:128
v_and_b32 v110, s54, v110
v_lshlrev_b32 v107, 16, v111
v_mfma_f32_16x16x32_bf16 v[224:227], a[44:47], v[116:119], v[224:227]
ds_read_b128 a[12:15], v21 offset:12288
v_and_b32 v111, s54, v111
v_mfma_f32_16x16x32_bf16 v[228:231], a[48:51], v[116:119], v[228:231]
ds_read_b128 a[16:19], v20 offset:18432
v_mfma_f32_16x16x32_bf16 v[232:235], a[52:55], v[116:119], v[232:235]
s_waitcnt lgkmcnt(5)
ds_read_b128 a[20:23], v21 offset:14336
v_mfma_f32_16x16x32_bf16 v[208:211], a[56:59], v[124:127], v[208:211]
ds_read_b128 a[24:27], v20 offset:20480
s_waitcnt vmcnt(9)
ds_read_b128 v[132:135], v11 offset:8192
v_lshlrev_b32 v112, 16, v116
v_mfma_f32_16x16x32_bf16 v[212:215], a[60:63], v[124:127], v[212:215]
ds_read_b128 a[28:31], v21 offset:16384
v_and_b32 v116, s54, v116
v_lshlrev_b32 v113, 16, v117
v_mfma_f32_16x16x32_bf16 v[216:219], a[64:67], v[124:127], v[216:219]
ds_read_b128 a[32:35], v20 offset:22528
v_and_b32 v117, s54, v117
v_lshlrev_b32 v114, 16, v118
v_mfma_f32_16x16x32_bf16 v[220:223], a[68:71], v[124:127], v[220:223]
s_waitcnt lgkmcnt(6)
ds_read_b128 a[36:39], v252 offset:192
v_and_b32 v118, s54, v118
v_lshlrev_b32 v115, 16, v119
v_mfma_f32_16x16x32_bf16 v[224:227], a[0:3], v[124:127], v[224:227]
s_barrier
ds_read_b128 a[40:43], v250 offset:0
v_mfma_f32_16x16x32_bf16 v[228:231], a[4:7], v[124:127], v[228:231]
ds_read_b128 a[44:47], v21 offset:18432
v_and_b32 v119, s54, v119
v_mfma_f32_16x16x32_bf16 v[232:235], a[8:11], v[124:127], v[232:235]
s_waitcnt lgkmcnt(5)
ds_read_b128 a[48:51], v250 offset:2048
v_mfma_f32_16x16x32_bf16 v[208:211], a[12:15], v[132:135], v[208:211]
ds_read_b128 a[52:55], v21 offset:20480
s_waitcnt vmcnt(8)
ds_read_b128 v[140:143], v10 offset:12288
buffer_load_dwordx4 v254, s[24:27], s51 offen lds
v_mfma_f32_16x16x32_bf16 v[212:215], a[16:19], v[132:135], v[212:215]
s_mov_b32 m0, s47
ds_read_b128 a[56:59], v250 offset:4096
v_lshlrev_b32 v120, 16, v124
v_and_b32 v124, s54, v124
v_mfma_f32_16x16x32_bf16 v[216:219], a[20:23], v[132:135], v[216:219]
ds_read_b128 a[60:63], v21 offset:22528
v_lshlrev_b32 v121, 16, v125
v_and_b32 v125, s54, v125
v_mfma_f32_16x16x32_bf16 v[220:223], a[24:27], v[132:135], v[220:223]
s_waitcnt lgkmcnt(6)
ds_read_b128 a[64:67], v252 offset:256
v_lshlrev_b32 v122, 16, v126
v_and_b32 v126, s54, v126
v_mfma_f32_16x16x32_bf16 v[224:227], a[28:31], v[132:135], v[224:227]
ds_read_b128 a[68:71], v251 offset:0
v_lshlrev_b32 v123, 16, v127
v_and_b32 v127, s54, v127
v_mfma_f32_16x16x32_bf16 v[228:231], a[32:35], v[132:135], v[228:231]
ds_read_b128 a[0:3], v250 offset:6144
v_mfma_f32_16x16x32_bf16 v[232:235], a[36:39], v[132:135], v[232:235]
s_waitcnt lgkmcnt(5)
ds_read_b128 a[4:7], v251 offset:2048
v_mfma_f32_16x16x32_bf16 v[208:211], a[40:43], v[140:143], v[208:211]
ds_read_b128 a[8:11], v250 offset:8192
s_waitcnt vmcnt(8)
ds_read_b128 v[148:151], v11 offset:16384
buffer_load_dwordx4 v253, s[28:31], m0 offen lds
v_mfma_f32_16x16x32_bf16 v[212:215], a[44:47], v[140:143], v[212:215]
s_add_u32 m0, s47, 4096
ds_read_b128 a[12:15], v251 offset:4096
v_lshlrev_b32 v128, 16, v132
v_and_b32 v132, s54, v132
v_mfma_f32_16x16x32_bf16 v[216:219], a[48:51], v[140:143], v[216:219]
ds_read_b128 a[16:19], v250 offset:10240
v_lshlrev_b32 v129, 16, v133
v_and_b32 v133, s54, v133
v_mfma_f32_16x16x32_bf16 v[220:223], a[52:55], v[140:143], v[220:223]
s_waitcnt lgkmcnt(6)
ds_read_b128 a[20:23], v252 offset:320
buffer_load_dwordx4 v253, s[28:31], m0 offen lds
v_mfma_f32_16x16x32_bf16 v[224:227], a[56:59], v[140:143], v[224:227]
s_add_u32 m0, s47, 8192
ds_read_b128 a[24:27], v250 offset:12288
v_lshlrev_b32 v130, 16, v134
v_and_b32 v134, s54, v134
v_mfma_f32_16x16x32_bf16 v[228:231], a[60:63], v[140:143], v[228:231]
ds_read_b128 a[28:31], v251 offset:6144
v_lshlrev_b32 v131, 16, v135
v_and_b32 v135, s54, v135
v_mfma_f32_16x16x32_bf16 v[232:235], a[64:67], v[140:143], v[232:235]
s_waitcnt lgkmcnt(5)
ds_read_b128 a[32:35], v250 offset:14336
buffer_load_dwordx4 v253, s[28:31], m0 offen lds
v_mfma_f32_16x16x32_bf16 v[208:211], a[68:71], v[148:151], v[208:211]
s_add_u32 m0, s47, 12288
ds_read_b128 a[36:39], v251 offset:8192
s_waitcnt vmcnt(10)
ds_read_b128 v[156:159], v10 offset:20480
v_lshlrev_b32 v136, 16, v140
v_mfma_f32_16x16x32_bf16 v[212:215], a[0:3], v[148:151], v[212:215]
ds_read_b128 a[40:43], v250 offset:16384
v_and_b32 v140, s54, v140
v_lshlrev_b32 v137, 16, v141
v_mfma_f32_16x16x32_bf16 v[216:219], a[4:7], v[148:151], v[216:219]
ds_read_b128 a[44:47], v251 offset:10240
buffer_load_dwordx4 v253, s[28:31], m0 offen lds
v_mfma_f32_16x16x32_bf16 v[220:223], a[8:11], v[148:151], v[220:223]
s_waitcnt lgkmcnt(6)
s_add_u32 m0, s47, 16384
ds_read_b128 a[48:51], v252 offset:384
v_and_b32 v141, s54, v141
v_lshlrev_b32 v138, 16, v142
v_mfma_f32_16x16x32_bf16 v[224:227], a[12:15], v[148:151], v[224:227]
s_waitcnt lgkmcnt(6)
ds_read_b128 a[52:55], v251 offset:12288
v_and_b32 v142, s54, v142
v_lshlrev_b32 v139, 16, v143
v_mfma_f32_16x16x32_bf16 v[228:231], a[16:19], v[148:151], v[228:231]
s_barrier
ds_read_b128 a[56:59], v250 offset:18432
buffer_load_dwordx4 v253, s[28:31], m0 offen lds
v_mfma_f32_16x16x32_bf16 v[232:235], a[20:23], v[148:151], v[232:235]
s_waitcnt lgkmcnt(5)
s_mov_b32 s44, 86528
ds_read_b128 a[60:63], v251 offset:14336
v_and_b32 v143, s54, v143
v_mfma_f32_16x16x32_bf16 v[208:211], a[24:27], v[156:159], v[208:211]
s_add_u32 m0, s48, 77824
ds_read_b128 a[64:67], v250 offset:20480
s_waitcnt vmcnt(11)
ds_read_b128 v[164:167], v11 offset:24576
v_lshlrev_b32 v144, 16, v148
v_mfma_f32_16x16x32_bf16 v[212:215], a[28:31], v[156:159], v[212:215]
ds_read_b128 a[68:71], v251 offset:16384
buffer_load_dwordx4 v254, s[24:27], s44 offen lds
v_mfma_f32_16x16x32_bf16 v[216:219], a[32:35], v[156:159], v[216:219]
s_add_u32 s52, s52, 86528
ds_read_b128 a[0:3], v250 offset:22528
v_and_b32 v148, s54, v148
v_lshlrev_b32 v145, 16, v149
v_mfma_f32_16x16x32_bf16 v[220:223], a[36:39], v[156:159], v[220:223]
s_waitcnt lgkmcnt(6)
s_add_u32 m0, s49, 137216
ds_read_b128 a[4:7], v252 offset:448
v_and_b32 v149, s54, v149
v_lshlrev_b32 v146, 16, v150
v_mfma_f32_16x16x32_bf16 v[224:227], a[40:43], v[156:159], v[224:227]
ds_read_b128 a[8:11], v250 offset:24576
buffer_load_dwordx4 v254, s[24:27], s52 offen lds
v_mfma_f32_16x16x32_bf16 v[228:231], a[44:47], v[156:159], v[228:231]
s_add_u32 s53, s53, 86528
ds_read_b128 a[12:15], v251 offset:18432
v_and_b32 v150, s54, v150
v_lshlrev_b32 v147, 16, v151
v_mfma_f32_16x16x32_bf16 v[232:235], a[48:51], v[156:159], v[232:235]
s_waitcnt lgkmcnt(5)
s_add_u32 m0, s50, 145920
ds_read_b128 a[16:19], v250 offset:26624
v_and_b32 v151, s54, v151
v_mfma_f32_16x16x32_bf16 v[208:211], a[52:55], v[164:167], v[208:211]
ds_read_b128 a[20:23], v251 offset:20480
s_waitcnt vmcnt(12)
ds_read_b128 v[172:175], v10 offset:28672
buffer_load_dwordx4 v253, s[24:27], s53 offen lds
v_mfma_f32_16x16x32_bf16 v[212:215], a[56:59], v[164:167], v[212:215]
ds_read_b128 a[24:27], v250 offset:28672
v_lshlrev_b32 v152, 16, v156
v_and_b32 v156, s54, v156
v_mfma_f32_16x16x32_bf16 v[216:219], a[60:63], v[164:167], v[216:219]
ds_read_b128 a[28:31], v251 offset:22528
v_lshlrev_b32 v153, 16, v157
v_and_b32 v157, s54, v157
v_mfma_f32_16x16x32_bf16 v[220:223], a[64:67], v[164:167], v[220:223]
s_waitcnt lgkmcnt(6)
ds_read_b128 a[32:35], v252 offset:512
buffer_load_dwordx4 v253, s[24:27], s53 offen offset:640 lds
v_mfma_f32_16x16x32_bf16 v[224:227], a[68:71], v[164:167], v[224:227]
s_add_u32 m0, s47, 20480
ds_read_b128 a[36:39], v251 offset:24576
v_lshlrev_b32 v154, 16, v158
v_and_b32 v158, s54, v158
v_mfma_f32_16x16x32_bf16 v[228:231], a[0:3], v[164:167], v[228:231]
ds_read_b128 a[40:43], v250 offset:30720
v_lshlrev_b32 v155, 16, v159
v_and_b32 v159, s54, v159
v_mfma_f32_16x16x32_bf16 v[232:235], a[4:7], v[164:167], v[232:235]
s_waitcnt lgkmcnt(5)
ds_read_b128 a[44:47], v251 offset:26624
buffer_load_dwordx4 v253, s[28:31], m0 offen lds
v_mfma_f32_16x16x32_bf16 v[208:211], a[8:11], v[172:175], v[208:211]
s_add_u32 m0, s47, 24576
ds_read_b128 a[48:51], v250 offset:32768
s_waitcnt vmcnt(14)
ds_read_b128 v[180:183], v11 offset:32768
v_lshlrev_b32 v160, 16, v164
v_mfma_f32_16x16x32_bf16 v[212:215], a[12:15], v[172:175], v[212:215]
ds_read_b128 a[52:55], v251 offset:28672
v_and_b32 v164, s54, v164
v_lshlrev_b32 v161, 16, v165
v_mfma_f32_16x16x32_bf16 v[216:219], a[16:19], v[172:175], v[216:219]
ds_read_b128 a[56:59], v250 offset:34816
buffer_load_dwordx4 v253, s[28:31], m0 offen lds
v_mfma_f32_16x16x32_bf16 v[220:223], a[20:23], v[172:175], v[220:223]
s_waitcnt lgkmcnt(6)
s_add_u32 m0, s47, 28672
ds_read_b128 a[60:63], v252 offset:576
v_and_b32 v165, s54, v165
v_lshlrev_b32 v162, 16, v166
v_mfma_f32_16x16x32_bf16 v[224:227], a[24:27], v[172:175], v[224:227]
ds_read_b128 a[64:67], v250 offset:36864
v_and_b32 v166, s54, v166
v_lshlrev_b32 v163, 16, v167
v_mfma_f32_16x16x32_bf16 v[228:231], a[28:31], v[172:175], v[228:231]
s_waitcnt lgkmcnt(4)
ds_read_b128 a[68:71], v251 offset:30720
buffer_load_dwordx4 v253, s[28:31], m0 offen lds
v_mfma_f32_16x16x32_bf16 v[232:235], a[32:35], v[172:175], v[232:235]
s_barrier
s_mov_b32 s45, 113152
ds_read_b128 a[0:3], v250 offset:38912
v_mfma_f32_16x16x32_bf16 v[208:211], a[36:39], v[180:183], v[208:211]
s_add_u32 m0, s48, 79872
ds_read_b128 a[4:7], v251 offset:32768
s_waitcnt vmcnt(15)
ds_read_b128 v[188:191], v10 offset:36864
v_and_b32 v167, s54, v167
v_mfma_f32_16x16x32_bf16 v[212:215], a[40:43], v[180:183], v[212:215]
ds_read_b128 a[8:11], v250 offset:40960
buffer_load_dwordx4 v254, s[24:27], s45 offen lds
v_mfma_f32_16x16x32_bf16 v[216:219], a[44:47], v[180:183], v[216:219]
s_mov_b32 s46, 139776
ds_read_b128 a[12:15], v251 offset:34816
v_lshlrev_b32 v168, 16, v172
v_and_b32 v172, s54, v172
v_mfma_f32_16x16x32_bf16 v[220:223], a[48:51], v[180:183], v[220:223]
s_waitcnt lgkmcnt(6)
s_add_u32 m0, s48, 81920
ds_read_b128 a[16:19], v252 offset:640
v_lshlrev_b32 v169, 16, v173
v_and_b32 v173, s54, v173
v_mfma_f32_16x16x32_bf16 v[224:227], a[52:55], v[180:183], v[224:227]
ds_read_b128 a[20:23], v251 offset:36864
buffer_load_dwordx4 v254, s[24:27], s46 offen lds
v_mfma_f32_16x16x32_bf16 v[228:231], a[56:59], v[180:183], v[228:231]
s_add_u32 m0, s47, 32768
ds_read_b128 a[24:27], v250 offset:43008
v_lshlrev_b32 v170, 16, v174
v_and_b32 v174, s54, v174
v_mfma_f32_16x16x32_bf16 v[232:235], a[60:63], v[180:183], v[232:235]
s_waitcnt lgkmcnt(5)
ds_read_b128 a[28:31], v251 offset:38912
v_lshlrev_b32 v171, 16, v175
v_and_b32 v175, s54, v175
v_mfma_f32_16x16x32_bf16 v[208:211], a[64:67], v[188:191], v[208:211]
ds_read_b128 a[32:35], v250 offset:45056
s_waitcnt vmcnt(16)
ds_read_b128 v[196:199], v11 offset:40960
buffer_load_dwordx4 v253, s[28:31], m0 offen lds
v_mfma_f32_16x16x32_bf16 v[212:215], a[68:71], v[188:191], v[212:215]
s_add_u32 m0, s48, 89984
ds_read_b128 a[36:39], v251 offset:40960
v_lshlrev_b32 v176, 16, v180
v_and_b32 v180, s54, v180
v_mfma_f32_16x16x32_bf16 v[216:219], a[0:3], v[188:191], v[216:219]
ds_read_b128 a[40:43], v250 offset:47104
v_lshlrev_b32 v177, 16, v181
v_and_b32 v181, s54, v181
v_mfma_f32_16x16x32_bf16 v[220:223], a[4:7], v[188:191], v[220:223]
s_waitcnt lgkmcnt(6)
ds_read_b128 a[44:47], v252 offset:704
buffer_load_dwordx4 v254, s[24:27], s44 offen offset:128 lds
v_mfma_f32_16x16x32_bf16 v[224:227], a[8:11], v[188:191], v[224:227]
s_add_u32 m0, s48, 92032
ds_read_b128 a[48:51], v250 offset:49152
v_lshlrev_b32 v178, 16, v182
v_and_b32 v182, s54, v182
v_mfma_f32_16x16x32_bf16 v[228:231], a[12:15], v[188:191], v[228:231]
ds_read_b128 a[52:55], v251 offset:43008
v_lshlrev_b32 v179, 16, v183
v_and_b32 v183, s54, v183
v_mfma_f32_16x16x32_bf16 v[232:235], a[16:19], v[188:191], v[232:235]
s_waitcnt lgkmcnt(5)
ds_read_b128 a[56:59], v250 offset:51200
buffer_load_dwordx4 v254, s[24:27], s45 offen offset:128 lds
v_mfma_f32_16x16x32_bf16 v[208:211], a[20:23], v[196:199], v[208:211]
s_waitcnt vmcnt(13) lgkmcnt(5)
s_add_u32 m0, s48, 94080
ds_read_b128 a[60:63], v251 offset:45056
ds_read_b128 v[204:207], v10 offset:45056
v_lshlrev_b32 v184, 16, v188
v_mfma_f32_16x16x32_bf16 v[212:215], a[24:27], v[196:199], v[212:215]
s_barrier
ds_read_b128 a[64:67], v250 offset:53248
v_mfma_f32_16x16x32_bf16 v[216:219], a[28:31], v[196:199], v[216:219]
ds_read_b128 a[68:71], v251 offset:47104
buffer_load_dwordx4 v254, s[24:27], s46 offen offset:128 lds
v_mfma_f32_16x16x32_bf16 v[220:223], a[32:35], v[196:199], v[220:223]
s_add_u32 m0, s47, 36864
ds_read_b128 a[0:3], v252 offset:768
v_and_b32 v188, s54, v188
v_lshlrev_b32 v185, 16, v189
v_mfma_f32_16x16x32_bf16 v[224:227], a[36:39], v[196:199], v[224:227]
s_waitcnt lgkmcnt(6)
ds_read_b128 a[4:7], v248 offset:0
v_and_b32 v189, s54, v189
v_lshlrev_b32 v186, 16, v190
v_mfma_f32_16x16x32_bf16 v[228:231], a[40:43], v[196:199], v[228:231]
ds_read_b128 a[8:11], v248 offset:208
buffer_load_dwordx4 v253, s[28:31], m0 offen lds
v_and_b32 v190, s54, v190
v_mfma_f32_16x16x32_bf16 v[232:235], a[44:47], v[196:199], v[232:235]
s_waitcnt lgkmcnt(5)
s_add_u32 m0, s47, 40960
ds_read_b128 a[12:15], v248 offset:6656
v_lshlrev_b32 v187, 16, v191
v_and_b32 v191, s54, v191
v_mfma_f32_16x16x32_bf16 v[208:211], a[48:51], v[204:207], v[208:211]
ds_read_b128 a[16:19], v248 offset:6864
v_lshlrev_b32 v192, 16, v196
v_and_b32 v196, s54, v196
v_mfma_f32_16x16x32_bf16 v[212:215], a[52:55], v[204:207], v[212:215]
ds_read_b128 a[20:23], v248 offset:64
buffer_load_dwordx4 v253, s[28:31], m0 offen lds
v_lshlrev_b32 v193, 16, v197
v_and_b32 v197, s54, v197
v_mfma_f32_16x16x32_bf16 v[216:219], a[56:59], v[204:207], v[216:219]
s_add_u32 m0, s47, 45056
ds_read_b128 a[24:27], v248 offset:272
v_lshlrev_b32 v194, 16, v198
v_and_b32 v198, s54, v198
v_mfma_f32_16x16x32_bf16 v[220:223], a[60:63], v[204:207], v[220:223]
s_waitcnt lgkmcnt(5)
ds_read_b128 a[28:31], v248 offset:6720
v_lshlrev_b32 v195, 16, v199
v_and_b32 v199, s54, v199
v_mfma_f32_16x16x32_bf16 v[224:227], a[64:67], v[204:207], v[224:227]
ds_read_b128 a[32:35], v248 offset:6928
buffer_load_dwordx4 v253, s[28:31], m0 offen lds
v_cvt_pk_bf16_f32 v208, v208, v212
v_cvt_pk_bf16_f32 v209, v209, v213
v_cvt_pk_bf16_f32 v210, v210, v214
v_cvt_pk_bf16_f32 v211, v211, v215
v_accvgpr_write_b32 a150, v208
v_accvgpr_write_b32 a151, v209
v_mfma_f32_16x16x32_bf16 v[228:231], a[68:71], v[204:207], v[228:231]
s_add_u32 m0, s48, 102144
ds_read_b128 a[36:39], v248 offset:128
v_accvgpr_write_b32 a152, v210
v_accvgpr_write_b32 a153, v211
v_mfma_f32_16x16x32_bf16 v[232:235], a[0:3], v[204:207], v[232:235]
s_waitcnt vmcnt(7) lgkmcnt(5)
ds_read_b128 a[40:43], v248 offset:336
v_cvt_pk_bf16_f32 v216, v216, v220
v_cvt_pk_bf16_f32 v217, v217, v221
v_mfma_f32_16x16x32_bf16 v[0:3], a[4:7], a[150:153], 1.0
s_barrier
ds_read_b128 a[44:47], v248 offset:6784
buffer_load_dwordx4 v254, s[24:27], s44 offen offset:256 lds
v_cvt_pk_bf16_f32 v218, v218, v222
v_cvt_pk_bf16_f32 v219, v219, v223
v_mfma_f32_16x16x32_bf16 v[4:7], a[8:11], a[150:153], 1.0
s_add_u32 m0, s48, 104192
ds_read_b128 a[48:51], v248 offset:6992
v_accvgpr_write_b32 a154, v216
v_accvgpr_write_b32 a155, v217
v_mfma_f32_16x16x32_bf16 v[8:11], a[12:15], a[150:153], 1.0
ds_read_b64 a[72:73], v249 offset:0
buffer_load_dwordx4 v254, s[24:27], s45 offen offset:256 lds
v_accvgpr_write_b32 a156, v218
v_accvgpr_write_b32 a157, v219
v_mfma_f32_16x16x32_bf16 v[12:15], a[16:19], a[150:153], 1.0
s_waitcnt lgkmcnt(5)
ds_read_b64 a[76:77], v249 offset:208
v_cvt_pk_bf16_f32 v224, v224, v228
v_cvt_pk_bf16_f32 v225, v225, v229
v_mfma_f32_16x16x32_bf16 v[0:3], a[20:23], a[154:157], v[0:3]
s_add_u32 m0, s48, 106240
ds_read_b64 a[78:79], v249 offset:6656
buffer_load_dwordx4 v254, s[24:27], s46 offen offset:256 lds
v_cvt_pk_bf16_f32 v226, v226, v230
v_cvt_pk_bf16_f32 v227, v227, v231
v_mfma_f32_16x16x32_bf16 v[4:7], a[24:27], a[154:157], v[4:7]
s_add_u32 m0, s47, 49152
ds_read_b64 a[82:83], v249 offset:6864
v_accvgpr_write_b32 a158, v224
v_accvgpr_write_b32 a159, v225
v_mfma_f32_16x16x32_bf16 v[8:11], a[28:31], a[154:157], v[8:11]
ds_read_b128 a[52:55], v248 offset:13312
buffer_load_dwordx4 v253, s[28:31], m0 offen lds
v_accvgpr_write_b32 a160, v226
v_accvgpr_write_b32 a161, v227
v_mfma_f32_16x16x32_bf16 v[12:15], a[32:35], a[154:157], v[12:15]
s_waitcnt lgkmcnt(5)
ds_read_b128 a[56:59], v248 offset:13520
v_cvt_pk_bf16_f32 v232, v232, v233
v_mfma_f32_16x16x32_bf16 v[0:3], a[36:39], a[158:161], v[0:3]
s_add_u32 m0, s48, 114304
ds_read_b128 a[60:63], v248 offset:13376
buffer_load_dwordx4 v254, s[24:27], s44 offen offset:384 lds
v_cvt_pk_bf16_f32 v234, v234, v235
v_mfma_f32_16x16x32_bf16 v[4:7], a[40:43], a[158:161], v[4:7]
s_add_u32 m0, s48, 116352
ds_read_b128 a[64:67], v248 offset:13584
ds_read_b128 a[68:71], v248 offset:13440
v_cndmask_b32_e64 v232, 0, v232, s[56:57]
v_cndmask_b32_e64 v234, 0, v234, s[56:57]
v_mfma_f32_16x16x32_bf16 v[8:11], a[44:47], a[158:161], v[8:11]
ds_read_b128 a[0:3], v248 offset:13648
buffer_load_dwordx4 v254, s[24:27], s45 offen offset:384 lds
v_accvgpr_write_b32 a164, v232
v_accvgpr_write_b32 a165, v234
v_mfma_f32_16x16x32_bf16 v[12:15], a[48:51], a[158:161], v[12:15]
s_waitcnt lgkmcnt(6)
ds_read_b64 a[84:85], v249 offset:13312
v_lshlrev_b32 v200, 16, v204
v_mfma_f32_16x16x32_bf16 v[0:3], a[72:75], a[164:167], v[0:3]
s_add_u32 m0, s48, 118400
ds_read_b64 a[88:89], v249 offset:13520
ds_read_b128 a[4:7], v250 offset:0
buffer_load_dwordx4 v254, s[24:27], s46 offen offset:384 lds
v_mfma_f32_16x16x32_bf16 v[4:7], a[74:77], a[162:165], v[4:7]
s_add_u32 s51, s51, 86528
ds_read_b128 a[8:11], v251 offset:55296
v_and_b32 v204, s54, v204
v_mfma_f32_16x16x32_bf16 v[8:11], a[78:81], a[164:167], v[8:11]
s_add_u32 m0, s47, 126976
ds_read_b128 a[12:15], v250 offset:2048
buffer_load_dwordx4 v254, s[24:27], s51 offen lds
v_lshlrev_b32 v201, 16, v205
v_and_b32 v205, s54, v205
v_mfma_f32_16x16x32_bf16 v[12:15], a[80:83], a[162:165], v[12:15]
s_waitcnt vmcnt(14) lgkmcnt(6)
ds_read_b128 a[16:19], v251 offset:57344
ds_read_b128 a[20:23], v250 offset:4096
v_lshlrev_b32 v202, 16, v206
v_and_b32 v206, s54, v206
v_mfma_f32_16x16x32_bf16 v[16:19], a[52:55], a[150:153], 1.0
s_barrier
ds_read_b128 a[24:27], v251 offset:59392
v_lshlrev_b32 v203, 16, v207
v_and_b32 v207, s54, v207
v_mfma_f32_16x16x32_bf16 v[20:23], a[56:59], a[150:153], 1.0
s_add_u32 s52, s52, 86528
ds_read_b128 a[28:31], v252 offset:6656
v_mul_f32 v244, v104, v0
v_mul_f32 v245, v108, v4
v_mfma_f32_16x16x32_bf16 v[16:19], a[60:63], a[154:157], v[16:19]
s_add_u32 m0, s49, 131072
ds_read_b128 a[32:35], v248 offset:19968
ds_read_b128 a[36:39], v248 offset:20176
buffer_load_dwordx4 v254, s[24:27], s52 offen lds
v_cvt_pk_bf16_f32 v236, v244, v245
v_mul_f32 v246, v105, v1
v_mfma_f32_16x16x32_bf16 v[20:23], a[64:67], a[154:157], v[20:23]
s_add_u32 s28, s28, 53248
s_addc_u32 s29, s29, 0
ds_read_b128 a[40:43], v248 offset:20032
v_mul_f32 v247, v109, v5
v_cvt_pk_bf16_f32 v237, v246, v247
v_mfma_f32_16x16x32_bf16 v[16:19], a[68:71], a[158:161], v[16:19]
s_waitcnt lgkmcnt(7)
ds_read_b128 a[44:47], v248 offset:20240
v_mul_f32 v244, v106, v2
v_mul_f32 v245, v110, v6
v_mfma_f32_16x16x32_bf16 v[20:23], a[0:3], a[158:161], v[20:23]
s_mov_b32 m0, s47
ds_read_b128 a[48:51], v248 offset:20096
ds_read_b128 a[52:55], v248 offset:20304
buffer_load_dwordx4 v253, s[28:31], m0 offen lds
v_cvt_pk_bf16_f32 v238, v244, v245
v_mul_f32 v246, v107, v3
v_mfma_f32_16x16x32_bf16 v[16:19], a[84:87], a[164:167], v[16:19]
s_add_u32 m0, s47, 4096
ds_read_b64 a[90:91], v249 offset:19968
v_mul_f32 v247, v111, v7
v_cvt_pk_bf16_f32 v239, v246, v247
v_mfma_f32_16x16x32_bf16 v[20:23], a[86:89], a[162:165], v[20:23]
ds_read_b64 a[94:95], v249 offset:20176
buffer_load_dwordx4 v253, s[28:31], m0 offen lds
v_mfma_f32_16x16x32_bf16 v[208:211], a[4:7], v[236:239], 0
s_add_u32 m0, s47, 8192
ds_read_b128 a[56:59], v251 offset:0
ds_read_b128 a[60:63], v250 offset:6144
v_mfma_f32_16x16x32_bf16 v[212:215], a[8:11], v[236:239], 0
ds_read_b128 a[64:67], v251 offset:2048
buffer_load_dwordx4 v253, s[28:31], m0 offen lds
v_mfma_f32_16x16x32_bf16 v[216:219], a[12:15], v[236:239], 0
s_waitcnt lgkmcnt(7)
ds_read_b128 a[68:71], v250 offset:8192
v_mul_f32 v244, v112, v8
v_mfma_f32_16x16x32_bf16 v[220:223], a[16:19], v[236:239], 0
s_add_u32 s53, s53, 86528
ds_read_b128 a[0:3], v251 offset:4096
v_mul_f32 v245, v116, v12
v_mfma_f32_16x16x32_bf16 v[224:227], a[20:23], v[236:239], 0
s_add_u32 m0, s50, 139264
ds_read_b128 a[4:7], v250 offset:10240
buffer_load_dwordx4 v253, s[24:27], s53 offen lds
v_mfma_f32_16x16x32_bf16 v[228:231], a[24:27], v[236:239], 0
ds_read_b128 a[8:11], v252 offset:6720
v_cvt_pk_bf16_f32 v240, v244, v245
v_mfma_f32_16x16x32_bf16 v[232:235], a[28:31], v[236:239], 0
ds_read_b128 a[12:15], v248 offset:26624
buffer_load_dwordx4 v253, s[24:27], s53 offen offset:640 lds
v_mfma_f32_16x16x32_bf16 v[24:27], a[32:35], a[150:153], 1.0
s_waitcnt vmcnt(14) lgkmcnt(5)
ds_read_b128 a[16:19], v248 offset:26832
v_mul_f32 v246, v113, v9
v_mfma_f32_16x16x32_bf16 v[28:31], a[36:39], a[150:153], 1.0
s_barrier
ds_read_b128 a[20:23], v248 offset:26688
v_mfma_f32_16x16x32_bf16 v[24:27], a[40:43], a[154:157], v[24:27]
s_add_u32 m0, s47, 12288
ds_read_b128 a[24:27], v248 offset:26896
buffer_load_dwordx4 v253, s[28:31], m0 offen lds
v_mfma_f32_16x16x32_bf16 v[28:31], a[44:47], a[154:157], v[28:31]
s_add_u32 m0, s47, 16384
ds_read_b128 a[28:31], v248 offset:26752
v_mul_f32 v247, v117, v13
v_cvt_pk_bf16_f32 v241, v246, v247
L_pad3:
s_cbranch_vccnz L_rT
v_mfma_f32_16x16x32_bf16 v[24:27], a[48:51], a[158:161], v[24:27]
L_M:
s_cbranch_vccnz L_rT
ds_read_b128 a[32:35], v248 offset:26960
buffer_load_dwordx4 v253, s[28:31], m0 offen lds
v_mul_f32 v244, v114, v10
v_mul_f32 v245, v118, v14
v_mfma_f32_16x16x32_bf16 v[28:31], a[52:55], a[158:161], v[28:31]
s_add_u32 m0, s47, 20480
ds_read_b64 a[96:97], v249 offset:26624
v_cvt_pk_bf16_f32 v242, v244, v245
v_mul_f32 v246, v115, v11
v_mfma_f32_16x16x32_bf16 v[24:27], a[90:93], a[164:167], v[24:27]
ds_read_b64 a[100:101], v249 offset:26832
buffer_load_dwordx4 v253, s[28:31], m0 offen lds
v_mul_f32 v247, v119, v15
v_cvt_pk_bf16_f32 v243, v246, v247
v_mfma_f32_16x16x32_bf16 v[28:31], a[92:95], a[162:165], v[28:31]
ds_read_b128 a[36:39], v250 offset:12288
v_mul_f32 v244, v120, v16
v_mfma_f32_16x16x32_bf16 v[208:211], a[56:59], v[240:243], v[208:211]
ds_read_b128 a[40:43], v251 offset:6144
v_mul_f32 v245, v124, v20
v_mfma_f32_16x16x32_bf16 v[212:215], a[60:63], v[240:243], v[212:215]
ds_read_b128 a[44:47], v250 offset:14336
v_cvt_pk_bf16_f32 v236, v244, v245
v_mfma_f32_16x16x32_bf16 v[216:219], a[64:67], v[240:243], v[216:219]
s_waitcnt lgkmcnt(5)
ds_read_b128 a[48:51], v251 offset:8192
v_mul_f32 v246, v121, v17
v_mfma_f32_16x16x32_bf16 v[220:223], a[68:71], v[240:243], v[220:223]
ds_read_b128 a[52:55], v250 offset:16384
v_mul_f32 v247, v125, v21
v_mfma_f32_16x16x32_bf16 v[224:227], a[0:3], v[240:243], v[224:227]
ds_read_b128 a[56:59], v251 offset:10240
v_cvt_pk_bf16_f32 v237, v246, v247
v_mfma_f32_16x16x32_bf16 v[228:231], a[4:7], v[240:243], v[228:231]
ds_read_b128 a[60:63], v252 offset:6784
v_mul_f32 v244, v122, v18
v_mfma_f32_16x16x32_bf16 v[232:235], a[8:11], v[240:243], v[232:235]
ds_read_b128 a[64:67], v248 offset:33280
v_mul_f32 v245, v126, v22
v_mfma_f32_16x16x32_bf16 v[32:35], a[12:15], a[150:153], 1.0
ds_read_b128 a[68:71], v248 offset:33488
v_cvt_pk_bf16_f32 v238, v244, v245
v_mfma_f32_16x16x32_bf16 v[36:39], a[16:19], a[150:153], 1.0
ds_read_b128 a[0:3], v248 offset:33344
v_mul_f32 v246, v123, v19
v_mfma_f32_16x16x32_bf16 v[32:35], a[20:23], a[154:157], v[32:35]
ds_read_b128 a[4:7], v248 offset:33552
v_mul_f32 v247, v127, v23
v_mfma_f32_16x16x32_bf16 v[36:39], a[24:27], a[154:157], v[36:39]
ds_read_b128 a[8:11], v248 offset:33408
v_cvt_pk_bf16_f32 v239, v246, v247
v_mfma_f32_16x16x32_bf16 v[32:35], a[28:31], a[158:161], v[32:35]
ds_read_b128 a[12:15], v248 offset:33616
v_mul_f32 v244, v128, v24
v_mfma_f32_16x16x32_bf16 v[36:39], a[32:35], a[158:161], v[36:39]
s_waitcnt lgkmcnt(5)
ds_read_b64 a[102:103], v249 offset:33280
v_mul_f32 v245, v132, v28
v_mfma_f32_16x16x32_bf16 v[32:35], a[96:99], a[164:167], v[32:35]
ds_read_b64 a[106:107], v249 offset:33488
v_cvt_pk_bf16_f32 v240, v244, v245
v_mfma_f32_16x16x32_bf16 v[36:39], a[98:101], a[162:165], v[36:39]
ds_read_b128 a[16:19], v251 offset:12288
v_mul_f32 v246, v129, v25
v_mfma_f32_16x16x32_bf16 v[208:211], a[36:39], v[236:239], v[208:211]
ds_read_b128 a[20:23], v250 offset:18432
v_mul_f32 v247, v133, v29
v_mfma_f32_16x16x32_bf16 v[212:215], a[40:43], v[236:239], v[212:215]
ds_read_b128 a[24:27], v251 offset:14336
v_cvt_pk_bf16_f32 v241, v246, v247
v_mfma_f32_16x16x32_bf16 v[216:219], a[44:47], v[236:239], v[216:219]
ds_read_b128 a[28:31], v250 offset:20480
v_mul_f32 v244, v130, v26
v_mfma_f32_16x16x32_bf16 v[220:223], a[48:51], v[236:239], v[220:223]
ds_read_b128 a[32:35], v251 offset:16384
v_mul_f32 v245, v134, v30
v_mfma_f32_16x16x32_bf16 v[224:227], a[52:55], v[236:239], v[224:227]
ds_read_b128 a[36:39], v250 offset:22528
v_cvt_pk_bf16_f32 v242, v244, v245
v_mfma_f32_16x16x32_bf16 v[228:231], a[56:59], v[236:239], v[228:231]
ds_read_b128 a[40:43], v252 offset:6848
v_mul_f32 v246, v131, v27
v_mfma_f32_16x16x32_bf16 v[232:235], a[60:63], v[236:239], v[232:235]
ds_read_b128 a[44:47], v248 offset:39936
v_mul_f32 v247, v135, v31
v_mfma_f32_16x16x32_bf16 v[40:43], a[64:67], a[150:153], 1.0
s_waitcnt lgkmcnt(5)
ds_read_b128 a[48:51], v248 offset:40144
v_cvt_pk_bf16_f32 v243, v246, v247
v_mfma_f32_16x16x32_bf16 v[44:47], a[68:71], a[150:153], 1.0
ds_read_b128 a[52:55], v248 offset:40000
v_mul_f32 v244, v136, v32
v_mfma_f32_16x16x32_bf16 v[40:43], a[0:3], a[154:157], v[40:43]
ds_read_b128 a[56:59], v248 offset:40208
v_mul_f32 v245, v140, v36
v_mfma_f32_16x16x32_bf16 v[44:47], a[4:7], a[154:157], v[44:47]
s_waitcnt vmcnt(6) lgkmcnt(5)
ds_read_b128 a[60:63], v248 offset:40064
v_cvt_pk_bf16_f32 v236, v244, v245
v_mfma_f32_16x16x32_bf16 v[40:43], a[8:11], a[158:161], v[40:43]
s_barrier
ds_read_b128 a[64:67], v248 offset:40272
v_mfma_f32_16x16x32_bf16 v[44:47], a[12:15], a[158:161], v[44:47]
s_add_u32 m0, s48, 77312
ds_read_b64 a[108:109], v249 offset:39936
buffer_load_dwordx4 v254, s[24:27], s44 offen offset:512 lds
v_mfma_f32_16x16x32_bf16 v[40:43], a[102:105], a[164:167], v[40:43]
s_add_u32 m0, s48, 79360
ds_read_b64 a[112:113], v249 offset:40144
v_mul_f32 v246, v137, v33
v_mfma_f32_16x16x32_bf16 v[44:47], a[104:107], a[162:165], v[44:47]
ds_read_b128 a[68:71], v250 offset:24576
v_mul_f32 v247, v141, v37
v_mfma_f32_16x16x32_bf16 v[208:211], a[16:19], v[240:243], v[208:211]
ds_read_b128 a[0:3], v251 offset:18432
buffer_load_dwordx4 v254, s[24:27], s45 offen offset:512 lds
v_mfma_f32_16x16x32_bf16 v[212:215], a[20:23], v[240:243], v[212:215]
s_add_u32 m0, s48, 81408
ds_read_b128 a[4:7], v250 offset:26624
v_cvt_pk_bf16_f32 v237, v246, v247
v_mfma_f32_16x16x32_bf16 v[216:219], a[24:27], v[240:243], v[216:219]
ds_read_b128 a[8:11], v251 offset:20480
v_mul_f32 v244, v138, v34
v_mfma_f32_16x16x32_bf16 v[220:223], a[28:31], v[240:243], v[220:223]
ds_read_b128 a[12:15], v250 offset:28672
buffer_load_dwordx4 v254, s[24:27], s46 offen offset:512 lds
v_mfma_f32_16x16x32_bf16 v[224:227], a[32:35], v[240:243], v[224:227]
s_add_u32 m0, s47, 24576
ds_read_b128 a[16:19], v251 offset:22528
v_mul_f32 v245, v142, v38
v_mfma_f32_16x16x32_bf16 v[228:231], a[36:39], v[240:243], v[228:231]
s_waitcnt lgkmcnt(5)
ds_read_b128 a[20:23], v252 offset:6912
v_cvt_pk_bf16_f32 v238, v244, v245
v_mfma_f32_16x16x32_bf16 v[232:235], a[40:43], v[240:243], v[232:235]
ds_read_b128 a[24:27], v248 offset:46592
buffer_load_dwordx4 v253, s[28:31], m0 offen lds
v_mfma_f32_16x16x32_bf16 v[48:51], a[44:47], a[150:153], 1.0
s_add_u32 m0, s47, 28672
ds_read_b128 a[28:31], v248 offset:46800
v_mul_f32 v246, v139, v35
v_mfma_f32_16x16x32_bf16 v[52:55], a[48:51], a[150:153], 1.0
ds_read_b128 a[32:35], v248 offset:46656
v_mul_f32 v247, v143, v39
v_mfma_f32_16x16x32_bf16 v[48:51], a[52:55], a[154:157], v[48:51]
ds_read_b128 a[36:39], v248 offset:46864
buffer_load_dwordx4 v253, s[28:31], m0 offen lds
v_mfma_f32_16x16x32_bf16 v[52:55], a[56:59], a[154:157], v[52:55]
s_add_u32 m0, s47, 32768
ds_read_b128 a[40:43], v248 offset:46720
v_cvt_pk_bf16_f32 v239, v246, v247
v_mfma_f32_16x16x32_bf16 v[48:51], a[60:63], a[158:161], v[48:51]
ds_read_b128 a[44:47], v248 offset:46928
v_mul_f32 v244, v144, v40
v_mfma_f32_16x16x32_bf16 v[52:55], a[64:67], a[158:161], v[52:55]
ds_read_b64 a[114:115], v249 offset:46592
buffer_load_dwordx4 v253, s[28:31], m0 offen lds
v_mfma_f32_16x16x32_bf16 v[48:51], a[108:111], a[164:167], v[48:51]
ds_read_b64 a[118:119], v249 offset:46800
v_mul_f32 v245, v148, v44
v_mfma_f32_16x16x32_bf16 v[52:55], a[110:113], a[162:165], v[52:55]
ds_read_b128 a[48:51], v251 offset:24576
v_cvt_pk_bf16_f32 v240, v244, v245
v_mfma_f32_16x16x32_bf16 v[208:211], a[68:71], v[236:239], v[208:211]
s_waitcnt lgkmcnt(5)
ds_read_b128 a[52:55], v250 offset:30720
v_mul_f32 v246, v145, v41
v_mfma_f32_16x16x32_bf16 v[212:215], a[0:3], v[236:239], v[212:215]
ds_read_b128 a[56:59], v251 offset:26624
v_mul_f32 v247, v149, v45
v_mfma_f32_16x16x32_bf16 v[216:219], a[4:7], v[236:239], v[216:219]
ds_read_b128 a[60:63], v250 offset:32768
v_cvt_pk_bf16_f32 v241, v246, v247
v_mfma_f32_16x16x32_bf16 v[220:223], a[8:11], v[236:239], v[220:223]
ds_read_b128 a[64:67], v251 offset:28672
v_mul_f32 v244, v146, v42
v_mfma_f32_16x16x32_bf16 v[224:227], a[12:15], v[236:239], v[224:227]
ds_read_b128 a[68:71], v250 offset:34816
v_mul_f32 v245, v150, v46
v_mfma_f32_16x16x32_bf16 v[228:231], a[16:19], v[236:239], v[228:231]
ds_read_b128 a[0:3], v252 offset:6976
v_cvt_pk_bf16_f32 v242, v244, v245
v_mfma_f32_16x16x32_bf16 v[232:235], a[20:23], v[236:239], v[232:235]
ds_read_b128 a[4:7], v248 offset:0
v_mul_f32 v246, v147, v43
v_mfma_f32_16x16x32_bf16 v[56:59], a[24:27], a[150:153], 1.0
ds_read_b128 a[8:11], v248 offset:208
v_mul_f32 v247, v151, v47
v_mfma_f32_16x16x32_bf16 v[60:63], a[28:31], a[150:153], 1.0
ds_read_b128 a[12:15], v248 offset:64
v_cvt_pk_bf16_f32 v243, v246, v247
v_mfma_f32_16x16x32_bf16 v[56:59], a[32:35], a[154:157], v[56:59]
ds_read_b128 a[16:19], v248 offset:272
v_mul_f32 v244, v152, v48
v_mfma_f32_16x16x32_bf16 v[60:63], a[36:39], a[154:157], v[60:63]
s_waitcnt lgkmcnt(5)
ds_read_b128 a[20:23], v248 offset:128
v_mul_f32 v245, v156, v52
v_mfma_f32_16x16x32_bf16 v[56:59], a[40:43], a[158:161], v[56:59]
ds_read_b128 a[24:27], v248 offset:336
v_cvt_pk_bf16_f32 v236, v244, v245
v_mfma_f32_16x16x32_bf16 v[60:63], a[44:47], a[158:161], v[60:63]
ds_read_b64 a[120:121], v249 offset:0
v_mul_f32 v246, v153, v49
v_mfma_f32_16x16x32_bf16 v[56:59], a[114:117], a[164:167], v[56:59]
s_waitcnt vmcnt(5) lgkmcnt(5)
ds_read_b64 a[124:125], v249 offset:208
v_mul_f32 v247, v157, v53
v_mfma_f32_16x16x32_bf16 v[60:63], a[116:119], a[162:165], v[60:63]
s_barrier
ds_read_b128 a[28:31], v250 offset:36864
v_mfma_f32_16x16x32_bf16 v[208:211], a[48:51], v[240:243], v[208:211]
s_add_u32 m0, s48, 89472
ds_read_b128 a[32:35], v251 offset:30720
buffer_load_dwordx4 v254, s[24:27], s44 offen offset:640 lds
v_mfma_f32_16x16x32_bf16 v[212:215], a[52:55], v[240:243], v[212:215]
s_add_u32 m0, s48, 91520
ds_read_b128 a[36:39], v250 offset:38912
v_cvt_pk_bf16_f32 v237, v246, v247
v_mfma_f32_16x16x32_bf16 v[216:219], a[56:59], v[240:243], v[216:219]
ds_read_b128 a[40:43], v251 offset:32768
v_mul_f32 v244, v154, v50
v_mfma_f32_16x16x32_bf16 v[220:223], a[60:63], v[240:243], v[220:223]
ds_read_b128 a[44:47], v250 offset:40960
buffer_load_dwordx4 v254, s[24:27], s45 offen offset:640 lds
v_mfma_f32_16x16x32_bf16 v[224:227], a[64:67], v[240:243], v[224:227]
s_add_u32 m0, s48, 93568
ds_read_b128 a[48:51], v251 offset:34816
v_mul_f32 v245, v158, v54
v_mfma_f32_16x16x32_bf16 v[228:231], a[68:71], v[240:243], v[228:231]
ds_read_b128 a[52:55], v252 offset:7040
v_cvt_pk_bf16_f32 v238, v244, v245
v_mfma_f32_16x16x32_bf16 v[232:235], a[0:3], v[240:243], v[232:235]
ds_read_b128 a[56:59], v248 offset:6656
buffer_load_dwordx4 v254, s[24:27], s46 offen offset:640 lds
v_mfma_f32_16x16x32_bf16 v[64:67], a[4:7], a[150:153], 1.0
s_add_u32 m0, s47, 36864
ds_read_b128 a[60:63], v248 offset:6864
v_mul_f32 v246, v155, v51
v_mfma_f32_16x16x32_bf16 v[68:71], a[8:11], a[150:153], 1.0
s_waitcnt lgkmcnt(5)
ds_read_b128 a[64:67], v248 offset:6720
v_mul_f32 v247, v159, v55
v_mfma_f32_16x16x32_bf16 v[64:67], a[12:15], a[154:157], v[64:67]
ds_read_b128 a[68:71], v248 offset:6928
buffer_load_dwordx4 v253, s[28:31], m0 offen lds
v_mfma_f32_16x16x32_bf16 v[68:71], a[16:19], a[154:157], v[68:71]
s_add_u32 m0, s47, 40960
ds_read_b128 a[0:3], v248 offset:6784
v_cvt_pk_bf16_f32 v239, v246, v247
v_mfma_f32_16x16x32_bf16 v[64:67], a[20:23], a[158:161], v[64:67]
ds_read_b128 a[4:7], v248 offset:6992
v_mul_f32 v244, v160, v56
v_mfma_f32_16x16x32_bf16 v[68:71], a[24:27], a[158:161], v[68:71]
ds_read_b64 a[126:127], v249 offset:6656
buffer_load_dwordx4 v253, s[28:31], m0 offen lds
v_mfma_f32_16x16x32_bf16 v[64:67], a[120:123], a[164:167], v[64:67]
s_add_u32 m0, s47, 45056
ds_read_b64 a[130:131], v249 offset:6864
v_mul_f32 v245, v164, v60
v_mfma_f32_16x16x32_bf16 v[68:71], a[122:125], a[162:165], v[68:71]
ds_read_b128 a[8:11], v251 offset:36864
v_cvt_pk_bf16_f32 v240, v244, v245
v_mfma_f32_16x16x32_bf16 v[208:211], a[28:31], v[236:239], v[208:211]
ds_read_b128 a[12:15], v250 offset:43008
buffer_load_dwordx4 v253, s[28:31], m0 offen lds
v_mfma_f32_16x16x32_bf16 v[212:215], a[32:35], v[236:239], v[212:215]
s_add_u32 m0, s47, 49152
ds_read_b128 a[16:19], v251 offset:38912
v_mul_f32 v246, v161, v57
v_mfma_f32_16x16x32_bf16 v[216:219], a[36:39], v[236:239], v[216:219]
ds_read_b128 a[20:23], v250 offset:45056
v_mul_f32 v247, v165, v61
v_mfma_f32_16x16x32_bf16 v[220:223], a[40:43], v[236:239], v[220:223]
s_waitcnt lgkmcnt(5)
ds_read_b128 a[24:27], v251 offset:40960
buffer_load_dwordx4 v253, s[28:31], m0 offen lds
v_mfma_f32_16x16x32_bf16 v[224:227], a[44:47], v[236:239], v[224:227]
ds_read_b128 a[28:31], v250 offset:47104
v_cvt_pk_bf16_f32 v241, v246, v247
v_mfma_f32_16x16x32_bf16 v[228:231], a[48:51], v[236:239], v[228:231]
ds_read_b128 a[32:35], v252 offset:7104
v_mul_f32 v244, v162, v58
v_mfma_f32_16x16x32_bf16 v[232:235], a[52:55], v[236:239], v[232:235]
ds_read_b128 a[36:39], v248 offset:13312
v_mul_f32 v245, v166, v62
v_mfma_f32_16x16x32_bf16 v[72:75], a[56:59], a[150:153], 1.0
ds_read_b128 a[40:43], v248 offset:13520
v_cvt_pk_bf16_f32 v242, v244, v245
v_mfma_f32_16x16x32_bf16 v[76:79], a[60:63], a[150:153], 1.0
ds_read_b128 a[44:47], v248 offset:13376
v_mul_f32 v246, v163, v59
v_mfma_f32_16x16x32_bf16 v[72:75], a[64:67], a[154:157], v[72:75]
ds_read_b128 a[48:51], v248 offset:13584
v_mul_f32 v247, v167, v63
v_mfma_f32_16x16x32_bf16 v[76:79], a[68:71], a[154:157], v[76:79]
ds_read_b128 a[52:55], v248 offset:13440
v_cvt_pk_bf16_f32 v243, v246, v247
v_mfma_f32_16x16x32_bf16 v[72:75], a[0:3], a[158:161], v[72:75]
ds_read_b128 a[56:59], v248 offset:13648
v_mul_f32 v244, v168, v64
v_mfma_f32_16x16x32_bf16 v[76:79], a[4:7], a[158:161], v[76:79]
ds_read_b64 a[132:133], v249 offset:13312
v_mul_f32 v245, v172, v68
v_mfma_f32_16x16x32_bf16 v[72:75], a[126:129], a[164:167], v[72:75]
s_waitcnt lgkmcnt(5)
ds_read_b64 a[136:137], v249 offset:13520
v_cvt_pk_bf16_f32 v236, v244, v245
v_mfma_f32_16x16x32_bf16 v[76:79], a[128:131], a[162:165], v[76:79]
ds_read_b128 a[60:63], v250 offset:0
v_mul_f32 v246, v169, v65
v_mfma_f32_16x16x32_bf16 v[208:211], a[8:11], v[240:243], v[208:211]
s_waitcnt vmcnt(5) lgkmcnt(5)
ds_read_b128 a[64:67], v251 offset:43008
v_mul_f32 v247, v173, v69
v_mfma_f32_16x16x32_bf16 v[212:215], a[12:15], v[240:243], v[212:215]
s_barrier
ds_read_b128 a[68:71], v250 offset:2048
v_mfma_f32_16x16x32_bf16 v[216:219], a[16:19], v[240:243], v[216:219]
s_mov_b32 s44, 173056
ds_read_b128 a[0:3], v251 offset:45056
v_cvt_pk_bf16_f32 v237, v246, v247
v_mfma_f32_16x16x32_bf16 v[220:223], a[20:23], v[240:243], v[220:223]
s_add_u32 m0, s48, 102400
ds_read_b128 a[4:7], v250 offset:4096
buffer_load_dwordx4 v254, s[24:27], s44 offen lds
v_mfma_f32_16x16x32_bf16 v[224:227], a[24:27], v[240:243], v[224:227]
s_add_u32 m0, s47, 156672
ds_read_b128 a[8:11], v251 offset:47104
v_mul_f32 v244, v170, v66
v_mfma_f32_16x16x32_bf16 v[228:231], a[28:31], v[240:243], v[228:231]
ds_read_b128 a[12:15], v252 offset:7168
v_mul_f32 v245, v174, v70
v_mfma_f32_16x16x32_bf16 v[232:235], a[32:35], v[240:243], v[232:235]
ds_read_b128 a[16:19], v248 offset:19968
buffer_load_dword v253, s[72:75], s69 idxen lds
v_mfma_f32_16x16x32_bf16 v[80:83], a[36:39], a[150:153], 1.0
s_mov_b32 s45, 199680
ds_read_b128 a[20:23], v248 offset:20176
v_cvt_pk_bf16_f32 v238, v244, v245
v_mfma_f32_16x16x32_bf16 v[84:87], a[40:43], a[150:153], 1.0
s_add_u32 m0, s48, 104448
ds_read_b128 a[24:27], v248 offset:20032
v_mul_f32 v246, v171, v67
v_mfma_f32_16x16x32_bf16 v[80:83], a[44:47], a[154:157], v[80:83]
ds_read_b128 a[28:31], v248 offset:20240
buffer_load_dwordx4 v254, s[24:27], s45 offen lds
v_mfma_f32_16x16x32_bf16 v[84:87], a[48:51], a[154:157], v[84:87]
s_waitcnt lgkmcnt(5)
ds_read_b128 a[32:35], v248 offset:20096
v_mul_f32 v247, v175, v71
v_mfma_f32_16x16x32_bf16 v[80:83], a[52:55], a[158:161], v[80:83]
s_mov_b32 s46, 226304
ds_read_b128 a[36:39], v248 offset:20304
v_cvt_pk_bf16_f32 v239, v246, v247
v_mfma_f32_16x16x32_bf16 v[84:87], a[56:59], a[158:161], v[84:87]
s_add_u32 m0, s48, 106496
ds_read_b64 a[138:139], v249 offset:19968
buffer_load_dwordx4 v254, s[24:27], s46 offen lds
v_mfma_f32_16x16x32_bf16 v[80:83], a[132:135], a[164:167], v[80:83]
s_add_u32 s28, s28, 53248
s_addc_u32 s29, s29, 0
ds_read_b64 a[142:143], v249 offset:20176
v_mul_f32 v244, v176, v72
v_mfma_f32_16x16x32_bf16 v[84:87], a[134:137], a[162:165], v[84:87]
s_mov_b32 m0, s47
ds_read_b128 a[40:43], v251 offset:0
v_mul_f32 v245, v180, v76
v_mfma_f32_16x16x32_bf16 v[208:211], a[60:63], v[236:239], v[208:211]
ds_read_b128 a[44:47], v250 offset:6144
buffer_load_dwordx4 v253, s[28:31], m0 offen lds
v_mfma_f32_16x16x32_bf16 v[212:215], a[64:67], v[236:239], v[212:215]
s_add_u32 m0, s47, 4096
ds_read_b128 a[48:51], v251 offset:2048
v_cvt_pk_bf16_f32 v240, v244, v245
v_mfma_f32_16x16x32_bf16 v[216:219], a[68:71], v[236:239], v[216:219]
ds_read_b128 a[52:55], v250 offset:8192
v_mul_f32 v246, v177, v73
v_mfma_f32_16x16x32_bf16 v[220:223], a[0:3], v[236:239], v[220:223]
ds_read_b128 a[56:59], v251 offset:4096
buffer_load_dwordx4 v253, s[28:31], m0 offen lds
v_mfma_f32_16x16x32_bf16 v[224:227], a[4:7], v[236:239], v[224:227]
s_add_u32 m0, s47, 8192
ds_read_b128 a[60:63], v250 offset:10240
v_mul_f32 v247, v181, v77
v_mfma_f32_16x16x32_bf16 v[228:231], a[8:11], v[236:239], v[228:231]
s_waitcnt lgkmcnt(5)
ds_read_b128 a[64:67], v252 offset:7232
v_cvt_pk_bf16_f32 v241, v246, v247
v_mfma_f32_16x16x32_bf16 v[232:235], a[12:15], v[236:239], v[232:235]
ds_read_b128 a[68:71], v248 offset:26624
buffer_load_dwordx4 v253, s[28:31], m0 offen lds
v_mfma_f32_16x16x32_bf16 v[88:91], a[16:19], a[150:153], 1.0
ds_read_b128 a[0:3], v248 offset:26832
v_mul_f32 v244, v178, v74
v_mfma_f32_16x16x32_bf16 v[92:95], a[20:23], a[150:153], 1.0
ds_read_b128 a[4:7], v248 offset:26688
v_mul_f32 v245, v182, v78
v_mfma_f32_16x16x32_bf16 v[88:91], a[24:27], a[154:157], v[88:91]
ds_read_b128 a[8:11], v248 offset:26896
v_cvt_pk_bf16_f32 v242, v244, v245
v_mfma_f32_16x16x32_bf16 v[92:95], a[28:31], a[154:157], v[92:95]
ds_read_b128 a[12:15], v248 offset:26752
v_mul_f32 v246, v179, v75
v_mfma_f32_16x16x32_bf16 v[88:91], a[32:35], a[158:161], v[88:91]
ds_read_b128 a[16:19], v248 offset:26960
v_mul_f32 v247, v183, v79
v_mfma_f32_16x16x32_bf16 v[92:95], a[36:39], a[158:161], v[92:95]
ds_read_b64 a[144:145], v249 offset:26624
v_cvt_pk_bf16_f32 v243, v246, v247
v_mfma_f32_16x16x32_bf16 v[88:91], a[138:141], a[164:167], v[88:91]
ds_read_b64 a[148:149], v249 offset:26832
v_mul_f32 v244, v184, v80
v_mfma_f32_16x16x32_bf16 v[92:95], a[140:143], a[162:165], v[92:95]
ds_read_b128 a[20:23], v250 offset:12288
v_mul_f32 v245, v188, v84
v_mfma_f32_16x16x32_bf16 v[208:211], a[40:43], v[240:243], v[208:211]
s_waitcnt lgkmcnt(5)
ds_read_b128 a[24:27], v251 offset:6144
v_cvt_pk_bf16_f32 v236, v244, v245
v_mfma_f32_16x16x32_bf16 v[212:215], a[44:47], v[240:243], v[212:215]
ds_read_b128 a[28:31], v250 offset:14336
v_mul_f32 v246, v185, v81
v_mfma_f32_16x16x32_bf16 v[216:219], a[48:51], v[240:243], v[216:219]
s_waitcnt vmcnt(8) lgkmcnt(5)
ds_read_b128 a[32:35], v251 offset:8192
v_mul_f32 v247, v189, v85
v_mfma_f32_16x16x32_bf16 v[220:223], a[52:55], v[240:243], v[220:223]
s_barrier
ds_read_b128 a[36:39], v250 offset:16384
v_mfma_f32_16x16x32_bf16 v[224:227], a[56:59], v[240:243], v[224:227]
s_add_u32 m0, s47, 12288
ds_read_b128 a[40:43], v251 offset:10240
buffer_load_dwordx4 v253, s[28:31], m0 offen lds
v_mfma_f32_16x16x32_bf16 v[228:231], a[60:63], v[240:243], v[228:231]
s_add_u32 m0, s48, 114560
ds_read_b128 a[44:47], v252 offset:7296
v_cvt_pk_bf16_f32 v237, v246, v247
v_mfma_f32_16x16x32_bf16 v[232:235], a[64:67], v[240:243], v[232:235]
ds_read_b128 a[48:51], v251 offset:12288
v_mul_f32 v244, v186, v82
v_mfma_f32_16x16x32_bf16 v[96:99], a[68:71], a[150:153], 1.0
ds_read_b128 a[52:55], v250 offset:18432
buffer_load_dwordx4 v254, s[24:27], s44 offen offset:128 lds
v_mfma_f32_16x16x32_bf16 v[100:103], a[0:3], a[150:153], 1.0
s_add_u32 m0, s48, 116608
ds_read_b128 a[56:59], v251 offset:14336
v_mul_f32 v245, v190, v86
v_mfma_f32_16x16x32_bf16 v[96:99], a[4:7], a[154:157], v[96:99]
ds_read_b128 a[60:63], v250 offset:20480
v_cvt_pk_bf16_f32 v238, v244, v245
v_mfma_f32_16x16x32_bf16 v[100:103], a[8:11], a[154:157], v[100:103]
ds_read_b128 a[64:67], v251 offset:16384
buffer_load_dwordx4 v254, s[24:27], s45 offen offset:128 lds
v_mfma_f32_16x16x32_bf16 v[96:99], a[12:15], a[158:161], v[96:99]
s_add_u32 m0, s48, 118656
ds_read_b128 a[68:71], v250 offset:22528
v_mul_f32 v246, v187, v83
v_mfma_f32_16x16x32_bf16 v[100:103], a[16:19], a[158:161], v[100:103]
s_waitcnt lgkmcnt(5)
ds_read_b128 a[0:3], v252 offset:7360
v_mul_f32 v247, v191, v87
v_mfma_f32_16x16x32_bf16 v[96:99], a[144:147], a[164:167], v[96:99]
ds_read_b128 a[4:7], v250 offset:55296
buffer_load_dwordx4 v254, s[24:27], s46 offen offset:128 lds
v_cvt_pk_bf16_f32 v239, v246, v247
v_mfma_f32_16x16x32_bf16 v[100:103], a[146:149], a[162:165], v[100:103]
s_add_u32 m0, s47, 16384
ds_read_b128 a[8:11], v251 offset:18432
v_mul_f32 v244, v192, v88
v_mfma_f32_16x16x32_bf16 v[208:211], a[20:23], v[236:239], v[208:211]
ds_read_b128 a[12:15], v250 offset:57344
v_mul_f32 v245, v196, v92
v_mfma_f32_16x16x32_bf16 v[212:215], a[24:27], v[236:239], v[212:215]
ds_read_b128 a[16:19], v251 offset:20480
buffer_load_dwordx4 v253, s[28:31], m0 offen lds
v_cvt_pk_bf16_f32 v240, v244, v245
v_mul_f32 v246, v193, v89
v_mfma_f32_16x16x32_bf16 v[216:219], a[28:31], v[236:239], v[216:219]
s_add_u32 m0, s47, 20480
ds_read_b128 a[20:23], v250 offset:59392
v_mul_f32 v247, v197, v93
v_cvt_pk_bf16_f32 v241, v246, v247
v_mfma_f32_16x16x32_bf16 v[220:223], a[32:35], v[236:239], v[220:223]
ds_read_b128 a[24:27], v251 offset:22528
v_mul_f32 v244, v194, v90
v_mul_f32 v245, v198, v94
v_mfma_f32_16x16x32_bf16 v[224:227], a[36:39], v[236:239], v[224:227]
ds_read_b128 a[28:31], v252 offset:7424
buffer_load_dwordx4 v253, s[28:31], m0 offen lds
v_cvt_pk_bf16_f32 v242, v244, v245
v_mul_f32 v246, v195, v91
v_mfma_f32_16x16x32_bf16 v[228:231], a[40:43], v[236:239], v[228:231]
ds_read_b128 a[32:35], v248 offset:33280
v_mul_f32 v247, v199, v95
v_cvt_pk_bf16_f32 v243, v246, v247
v_mfma_f32_16x16x32_bf16 v[232:235], a[44:47], v[236:239], v[232:235]
ds_read_b128 a[36:39], v248 offset:33488
v_mul_f32 v244, v200, v96
v_mfma_f32_16x16x32_bf16 v[208:211], a[48:51], v[240:243], v[208:211]
s_waitcnt lgkmcnt(5)
ds_read_b128 a[40:43], v248 offset:39936
v_mul_f32 v245, v204, v100
v_mfma_f32_16x16x32_bf16 v[212:215], a[52:55], v[240:243], v[212:215]
ds_read_b128 a[44:47], v248 offset:40144
v_cvt_pk_bf16_f32 v236, v244, v245
v_mul_f32 v246, v201, v97
v_mfma_f32_16x16x32_bf16 v[216:219], a[56:59], v[240:243], v[216:219]
ds_read_b128 a[48:51], v248 offset:33344
v_mul_f32 v247, v205, v101
v_cvt_pk_bf16_f32 v237, v246, v247
v_mfma_f32_16x16x32_bf16 v[220:223], a[60:63], v[240:243], v[220:223]
ds_read_b128 a[52:55], v248 offset:33552
v_mul_f32 v244, v202, v98
v_mul_f32 v245, v206, v102
v_mfma_f32_16x16x32_bf16 v[224:227], a[64:67], v[240:243], v[224:227]
ds_read_b128 a[56:59], v248 offset:40000
v_cvt_pk_bf16_f32 v238, v244, v245
v_mul_f32 v246, v203, v99
v_mfma_f32_16x16x32_bf16 v[228:231], a[68:71], v[240:243], v[228:231]
ds_read_b128 a[60:63], v248 offset:40208
v_mul_f32 v247, v207, v103
v_cvt_pk_bf16_f32 v239, v246, v247
v_mfma_f32_16x16x32_bf16 v[232:235], a[0:3], v[240:243], v[232:235]
ds_read_b128 a[64:67], v248 offset:33408
v_mfma_f32_16x16x32_bf16 v[208:211], a[4:7], v[236:239], v[208:211]
ds_read_b128 a[68:71], v248 offset:33616
v_mfma_f32_16x16x32_bf16 v[212:215], a[8:11], v[236:239], v[212:215]
ds_read_b128 a[0:3], v248 offset:40064
v_mfma_f32_16x16x32_bf16 v[216:219], a[12:15], v[236:239], v[216:219]
ds_read_b128 a[4:7], v248 offset:40272
v_mfma_f32_16x16x32_bf16 v[220:223], a[16:19], v[236:239], v[220:223]
s_waitcnt lgkmcnt(5)
ds_read_b64 a[72:73], v249 offset:33280
v_mfma_f32_16x16x32_bf16 v[224:227], a[20:23], v[236:239], v[224:227]
ds_read_b64 a[76:77], v249 offset:33488
v_cvt_pk_bf16_f32 v208, v208, v212
v_cvt_pk_bf16_f32 v209, v209, v213
v_cvt_pk_bf16_f32 v210, v210, v214
v_cvt_pk_bf16_f32 v211, v211, v215
v_accvgpr_write_b32 a150, v208
v_accvgpr_write_b32 a151, v209
v_mfma_f32_16x16x32_bf16 v[228:231], a[24:27], v[236:239], v[228:231]
ds_read_b64 a[78:79], v249 offset:39936
v_accvgpr_write_b32 a152, v210
v_accvgpr_write_b32 a153, v211
v_mfma_f32_16x16x32_bf16 v[232:235], a[28:31], v[236:239], v[232:235]
s_waitcnt vmcnt(5) lgkmcnt(5)
ds_read_b64 a[82:83], v249 offset:40144
v_cvt_pk_bf16_f32 v216, v216, v220
v_cvt_pk_bf16_f32 v217, v217, v221
v_mfma_f32_16x16x32_bf16 v[0:3], a[32:35], a[150:153], v[0:3]
s_barrier
ds_read_b128 a[8:11], v248 offset:46592
v_cvt_pk_bf16_f32 v218, v218, v222
v_cvt_pk_bf16_f32 v219, v219, v223
v_mfma_f32_16x16x32_bf16 v[4:7], a[36:39], a[150:153], v[4:7]
s_add_u32 m0, s47, 24576
ds_read_b128 a[12:15], v248 offset:46800
buffer_load_dwordx4 v253, s[28:31], m0 offen lds
v_accvgpr_write_b32 a154, v216
v_accvgpr_write_b32 a155, v217
v_mfma_f32_16x16x32_bf16 v[8:11], a[40:43], a[150:153], v[8:11]
s_add_u32 m0, s48, 77568
ds_read_b128 a[16:19], v248 offset:46656
v_accvgpr_write_b32 a156, v218
v_accvgpr_write_b32 a157, v219
v_mfma_f32_16x16x32_bf16 v[12:15], a[44:47], a[150:153], v[12:15]
ds_read_b128 a[20:23], v248 offset:46864
v_cvt_pk_bf16_f32 v224, v224, v228
v_cvt_pk_bf16_f32 v225, v225, v229
v_mfma_f32_16x16x32_bf16 v[0:3], a[48:51], a[154:157], v[0:3]
L_pad4:
s_cbranch_vccnz L_rT
ds_read_b128 a[24:27], v248 offset:46720
buffer_load_dwordx4 v254, s[24:27], s44 offen offset:256 lds
v_cvt_pk_bf16_f32 v226, v226, v230
v_cvt_pk_bf16_f32 v227, v227, v231
v_mfma_f32_16x16x32_bf16 v[4:7], a[52:55], a[154:157], v[4:7]
s_add_u32 m0, s48, 79616
ds_read_b128 a[28:31], v248 offset:46928
v_accvgpr_write_b32 a158, v224
v_accvgpr_write_b32 a159, v225
v_mfma_f32_16x16x32_bf16 v[8:11], a[56:59], a[154:157], v[8:11]
ds_read_b64 a[84:85], v249 offset:46592
v_accvgpr_write_b32 a160, v226
v_accvgpr_write_b32 a161, v227
v_mfma_f32_16x16x32_bf16 v[12:15], a[60:63], a[154:157], v[12:15]
ds_read_b64 a[88:89], v249 offset:46800
buffer_load_dwordx4 v254, s[24:27], s45 offen offset:256 lds
v_mfma_f32_16x16x32_bf16 v[0:3], a[64:67], a[158:161], v[0:3]
s_add_u32 m0, s48, 81664
ds_read_b128 a[32:35], v250 offset:24576
v_cvt_pk_bf16_f32 v232, v232, v233
v_cvt_pk_bf16_f32 v234, v234, v235
v_mfma_f32_16x16x32_bf16 v[4:7], a[68:71], a[158:161], v[4:7]
s_waitcnt lgkmcnt(5)
ds_read_b128 a[36:39], v251 offset:49152
v_cndmask_b32_e64 v232, 0, v232, s[56:57]
v_cndmask_b32_e64 v234, 0, v234, s[56:57]
v_mfma_f32_16x16x32_bf16 v[8:11], a[0:3], a[158:161], v[8:11]
ds_read_b128 a[40:43], v250 offset:26624
buffer_load_dwordx4 v254, s[24:27], s46 offen offset:256 lds
v_accvgpr_write_b32 a170, v232
v_accvgpr_write_b32 a171, v234
v_mfma_f32_16x16x32_bf16 v[12:15], a[4:7], a[158:161], v[12:15]
s_add_u32 m0, s47, 28672
ds_read_b128 a[44:47], v251 offset:51200
v_mfma_f32_16x16x32_bf16 v[0:3], a[72:75], a[170:173], v[0:3]
ds_read_b128 a[48:51], v250 offset:28672
v_mfma_f32_16x16x32_bf16 v[4:7], a[74:77], a[168:171], v[4:7]
ds_read_b128 a[52:55], v251 offset:53248
buffer_load_dwordx4 v253, s[28:31], m0 offen lds
v_mfma_f32_16x16x32_bf16 v[8:11], a[78:81], a[170:173], v[8:11]
s_add_u32 m0, s48, 89728
ds_read_b128 a[56:59], v252 offset:0
v_mfma_f32_16x16x32_bf16 v[12:15], a[80:83], a[168:171], v[12:15]
ds_read_b128 a[60:63], v248 offset:0
v_mfma_f32_16x16x32_bf16 v[16:19], a[8:11], a[150:153], v[16:19]
ds_read_b128 a[64:67], v248 offset:208
buffer_load_dwordx4 v254, s[24:27], s44 offen offset:384 lds
v_mfma_f32_16x16x32_bf16 v[20:23], a[12:15], a[150:153], v[20:23]
s_add_u32 m0, s48, 91776
ds_read_b128 a[68:71], v248 offset:64
v_mul_f32 v244, v104, v0
v_mul_f32 v245, v108, v4
v_mfma_f32_16x16x32_bf16 v[16:19], a[16:19], a[154:157], v[16:19]
ds_read_b128 a[0:3], v248 offset:272
v_cvt_pk_bf16_f32 v236, v244, v245
v_mul_f32 v246, v105, v1
v_mfma_f32_16x16x32_bf16 v[20:23], a[20:23], a[154:157], v[20:23]
s_waitcnt lgkmcnt(5)
ds_read_b128 a[4:7], v248 offset:128
buffer_load_dwordx4 v254, s[24:27], s45 offen offset:384 lds
v_mul_f32 v247, v109, v5
v_cvt_pk_bf16_f32 v237, v246, v247
v_mfma_f32_16x16x32_bf16 v[16:19], a[24:27], a[158:161], v[16:19]
s_add_u32 m0, s48, 93824
ds_read_b128 a[8:11], v248 offset:336
v_mul_f32 v244, v106, v2
v_mul_f32 v245, v110, v6
v_mfma_f32_16x16x32_bf16 v[20:23], a[28:31], a[158:161], v[20:23]
ds_read_b64 a[90:91], v249 offset:0
v_cvt_pk_bf16_f32 v238, v244, v245
v_mul_f32 v246, v107, v3
v_mfma_f32_16x16x32_bf16 v[16:19], a[84:87], a[170:173], v[16:19]
ds_read_b64 a[94:95], v249 offset:208
buffer_load_dwordx4 v254, s[24:27], s46 offen offset:384 lds
v_mul_f32 v247, v111, v7
v_cvt_pk_bf16_f32 v239, v246, v247
v_mfma_f32_16x16x32_bf16 v[20:23], a[86:89], a[168:171], v[20:23]
ds_read_b128 a[12:15], v251 offset:24576
v_mul_f32 v244, v112, v8
v_mfma_f32_16x16x32_bf16 v[208:211], a[32:35], v[236:239], 0
ds_read_b128 a[16:19], v250 offset:30720
v_mul_f32 v245, v116, v12
v_mfma_f32_16x16x32_bf16 v[212:215], a[36:39], v[236:239], 0
ds_read_b128 a[20:23], v251 offset:26624
v_cvt_pk_bf16_f32 v240, v244, v245
v_mfma_f32_16x16x32_bf16 v[216:219], a[40:43], v[236:239], 0
ds_read_b128 a[24:27], v250 offset:32768
v_mul_f32 v246, v113, v9
v_mfma_f32_16x16x32_bf16 v[220:223], a[44:47], v[236:239], 0
ds_read_b128 a[28:31], v251 offset:28672
v_mul_f32 v247, v117, v13
v_mfma_f32_16x16x32_bf16 v[224:227], a[48:51], v[236:239], 0
ds_read_b128 a[32:35], v250 offset:34816
v_cvt_pk_bf16_f32 v241, v246, v247
v_mfma_f32_16x16x32_bf16 v[228:231], a[52:55], v[236:239], 0
s_waitcnt lgkmcnt(5)
ds_read_b128 a[36:39], v252 offset:64
v_mul_f32 v244, v114, v10
v_mfma_f32_16x16x32_bf16 v[232:235], a[56:59], v[236:239], 0
ds_read_b128 a[40:43], v248 offset:6656
v_mul_f32 v245, v118, v14
v_mfma_f32_16x16x32_bf16 v[24:27], a[60:63], a[150:153], v[24:27]
s_waitcnt vmcnt(7) lgkmcnt(5)
ds_read_b128 a[44:47], v248 offset:6864
v_cvt_pk_bf16_f32 v242, v244, v245
v_mfma_f32_16x16x32_bf16 v[28:31], a[64:67], a[150:153], v[28:31]
s_barrier
ds_read_b128 a[48:51], v248 offset:6720
v_mfma_f32_16x16x32_bf16 v[24:27], a[68:71], a[154:157], v[24:27]
s_add_u32 m0, s47, 32768
ds_read_b128 a[52:55], v248 offset:6928
buffer_load_dwordx4 v253, s[28:31], m0 offen lds
v_mfma_f32_16x16x32_bf16 v[28:31], a[0:3], a[154:157], v[28:31]
s_add_u32 m0, s47, 36864
ds_read_b128 a[56:59], v248 offset:6784
v_mul_f32 v246, v115, v11
v_mfma_f32_16x16x32_bf16 v[24:27], a[4:7], a[158:161], v[24:27]
ds_read_b128 a[60:63], v248 offset:6992
v_mul_f32 v247, v119, v15
v_mfma_f32_16x16x32_bf16 v[28:31], a[8:11], a[158:161], v[28:31]
ds_read_b64 a[96:97], v249 offset:6656
buffer_load_dwordx4 v253, s[28:31], m0 offen lds
v_mfma_f32_16x16x32_bf16 v[24:27], a[90:93], a[170:173], v[24:27]
s_add_u32 m0, s47, 40960
ds_read_b64 a[100:101], v249 offset:6864
v_cvt_pk_bf16_f32 v243, v246, v247
v_mfma_f32_16x16x32_bf16 v[28:31], a[92:95], a[168:171], v[28:31]
ds_read_b128 a[64:67], v250 offset:36864
v_mul_f32 v244, v120, v16
v_mfma_f32_16x16x32_bf16 v[208:211], a[12:15], v[240:243], v[208:211]
ds_read_b128 a[68:71], v251 offset:30720
buffer_load_dwordx4 v253, s[28:31], m0 offen lds
v_mfma_f32_16x16x32_bf16 v[212:215], a[16:19], v[240:243], v[212:215]
s_add_u32 m0, s47, 45056
ds_read_b128 a[0:3], v250 offset:38912
v_mul_f32 v245, v124, v20
v_mfma_f32_16x16x32_bf16 v[216:219], a[20:23], v[240:243], v[216:219]
s_waitcnt lgkmcnt(5)
ds_read_b128 a[4:7], v251 offset:32768
v_cvt_pk_bf16_f32 v236, v244, v245
v_mfma_f32_16x16x32_bf16 v[220:223], a[24:27], v[240:243], v[220:223]
ds_read_b128 a[8:11], v250 offset:40960
buffer_load_dwordx4 v253, s[28:31], m0 offen lds
v_mfma_f32_16x16x32_bf16 v[224:227], a[28:31], v[240:243], v[224:227]
s_add_u32 m0, s47, 49152
ds_read_b128 a[12:15], v251 offset:34816
v_mul_f32 v246, v121, v17
v_mfma_f32_16x16x32_bf16 v[228:231], a[32:35], v[240:243], v[228:231]
ds_read_b128 a[16:19], v252 offset:128
v_mul_f32 v247, v125, v21
v_mfma_f32_16x16x32_bf16 v[232:235], a[36:39], v[240:243], v[232:235]
ds_read_b128 a[20:23], v248 offset:13312
buffer_load_dwordx4 v253, s[28:31], m0 offen lds
v_mfma_f32_16x16x32_bf16 v[32:35], a[40:43], a[150:153], v[32:35]
s_add_u32 s28, s28, 53248
s_addc_u32 s29, s29, 0
ds_read_b128 a[24:27], v248 offset:13520
v_cvt_pk_bf16_f32 v237, v246, v247
v_mfma_f32_16x16x32_bf16 v[36:39], a[44:47], a[150:153], v[36:39]
s_mov_b32 m0, s47
ds_read_b128 a[28:31], v248 offset:13376
v_mul_f32 v244, v122, v18
v_mfma_f32_16x16x32_bf16 v[32:35], a[48:51], a[154:157], v[32:35]
ds_read_b128 a[32:35], v248 offset:13584
buffer_load_dwordx4 v253, s[28:31], m0 offen lds
v_mfma_f32_16x16x32_bf16 v[36:39], a[52:55], a[154:157], v[36:39]
ds_read_b128 a[36:39], v248 offset:13440
v_mul_f32 v245, v126, v22
v_mfma_f32_16x16x32_bf16 v[32:35], a[56:59], a[158:161], v[32:35]
ds_read_b128 a[40:43], v248 offset:13648
v_cvt_pk_bf16_f32 v238, v244, v245
v_mfma_f32_16x16x32_bf16 v[36:39], a[60:63], a[158:161], v[36:39]
s_waitcnt lgkmcnt(5)
ds_read_b64 a[102:103], v249 offset:13312
v_mul_f32 v246, v123, v19
v_mfma_f32_16x16x32_bf16 v[32:35], a[96:99], a[170:173], v[32:35]
ds_read_b64 a[106:107], v249 offset:13520
v_mul_f32 v247, v127, v23
v_cvt_pk_bf16_f32 v239, v246, v247
v_mfma_f32_16x16x32_bf16 v[36:39], a[98:101], a[168:171], v[36:39]
ds_read_b128 a[44:47], v251 offset:36864
v_mul_f32 v244, v128, v24
v_mfma_f32_16x16x32_bf16 v[208:211], a[64:67], v[236:239], v[208:211]
ds_read_b128 a[48:51], v250 offset:43008
v_mul_f32 v245, v132, v28
v_mfma_f32_16x16x32_bf16 v[212:215], a[68:71], v[236:239], v[212:215]
ds_read_b128 a[52:55], v251 offset:38912
v_cvt_pk_bf16_f32 v240, v244, v245
v_mfma_f32_16x16x32_bf16 v[216:219], a[0:3], v[236:239], v[216:219]
ds_read_b128 a[56:59], v250 offset:45056
v_mul_f32 v246, v129, v25
v_mfma_f32_16x16x32_bf16 v[220:223], a[4:7], v[236:239], v[220:223]
ds_read_b128 a[60:63], v251 offset:40960
v_mul_f32 v247, v133, v29
v_mfma_f32_16x16x32_bf16 v[224:227], a[8:11], v[236:239], v[224:227]
ds_read_b128 a[64:67], v250 offset:47104
v_cvt_pk_bf16_f32 v241, v246, v247
v_mfma_f32_16x16x32_bf16 v[228:231], a[12:15], v[236:239], v[228:231]
ds_read_b128 a[68:71], v252 offset:192
v_mul_f32 v244, v130, v26
v_mfma_f32_16x16x32_bf16 v[232:235], a[16:19], v[236:239], v[232:235]
ds_read_b128 a[0:3], v248 offset:19968
v_mul_f32 v245, v134, v30
v_mfma_f32_16x16x32_bf16 v[40:43], a[20:23], a[150:153], v[40:43]
s_waitcnt lgkmcnt(5)
ds_read_b128 a[4:7], v248 offset:20176
v_cvt_pk_bf16_f32 v242, v244, v245
v_mfma_f32_16x16x32_bf16 v[44:47], a[24:27], a[150:153], v[44:47]
ds_read_b128 a[8:11], v248 offset:20032
v_mul_f32 v246, v131, v27
v_mfma_f32_16x16x32_bf16 v[40:43], a[28:31], a[154:157], v[40:43]
ds_read_b128 a[12:15], v248 offset:20240
v_mul_f32 v247, v135, v31
v_mfma_f32_16x16x32_bf16 v[44:47], a[32:35], a[154:157], v[44:47]
s_waitcnt vmcnt(4) lgkmcnt(5)
ds_read_b128 a[16:19], v248 offset:20096
v_cvt_pk_bf16_f32 v243, v246, v247
v_mfma_f32_16x16x32_bf16 v[40:43], a[36:39], a[158:161], v[40:43]
s_barrier
ds_read_b128 a[20:23], v248 offset:20304
v_mfma_f32_16x16x32_bf16 v[44:47], a[40:43], a[158:161], v[44:47]
s_add_u32 m0, s48, 101888
ds_read_b64 a[108:109], v249 offset:19968
buffer_load_dwordx4 v254, s[24:27], s44 offen offset:512 lds
v_mfma_f32_16x16x32_bf16 v[40:43], a[102:105], a[170:173], v[40:43]
s_add_u32 m0, s48, 103936
ds_read_b64 a[112:113], v249 offset:20176
v_mul_f32 v244, v136, v32
v_mfma_f32_16x16x32_bf16 v[44:47], a[104:107], a[168:171], v[44:47]
ds_read_b128 a[24:27], v250 offset:0
v_mul_f32 v245, v140, v36
v_mfma_f32_16x16x32_bf16 v[208:211], a[44:47], v[240:243], v[208:211]
ds_read_b128 a[28:31], v251 offset:43008
buffer_load_dwordx4 v254, s[24:27], s45 offen offset:512 lds
v_mfma_f32_16x16x32_bf16 v[212:215], a[48:51], v[240:243], v[212:215]
s_add_u32 m0, s48, 105984
ds_read_b128 a[32:35], v250 offset:2048
v_cvt_pk_bf16_f32 v236, v244, v245
v_mfma_f32_16x16x32_bf16 v[216:219], a[52:55], v[240:243], v[216:219]
ds_read_b128 a[36:39], v251 offset:45056
v_mul_f32 v246, v137, v33
v_mfma_f32_16x16x32_bf16 v[220:223], a[56:59], v[240:243], v[220:223]
ds_read_b128 a[40:43], v250 offset:4096
buffer_load_dwordx4 v254, s[24:27], s46 offen offset:512 lds
v_mfma_f32_16x16x32_bf16 v[224:227], a[60:63], v[240:243], v[224:227]
s_add_u32 m0, s47, 4096
ds_read_b128 a[44:47], v251 offset:47104
v_mul_f32 v247, v141, v37
v_mfma_f32_16x16x32_bf16 v[228:231], a[64:67], v[240:243], v[228:231]
s_waitcnt lgkmcnt(5)
ds_read_b128 a[48:51], v252 offset:256
v_cvt_pk_bf16_f32 v237, v246, v247
v_mfma_f32_16x16x32_bf16 v[232:235], a[68:71], v[240:243], v[232:235]
ds_read_b128 a[52:55], v248 offset:26624
buffer_load_dwordx4 v253, s[28:31], m0 offen lds
v_mfma_f32_16x16x32_bf16 v[48:51], a[0:3], a[150:153], v[48:51]
s_add_u32 m0, s47, 8192
ds_read_b128 a[56:59], v248 offset:26832
v_mul_f32 v244, v138, v34
v_mfma_f32_16x16x32_bf16 v[52:55], a[4:7], a[150:153], v[52:55]
ds_read_b128 a[60:63], v248 offset:26688
v_mul_f32 v245, v142, v38
v_mfma_f32_16x16x32_bf16 v[48:51], a[8:11], a[154:157], v[48:51]
ds_read_b128 a[64:67], v248 offset:26896
buffer_load_dwordx4 v253, s[28:31], m0 offen lds
v_mfma_f32_16x16x32_bf16 v[52:55], a[12:15], a[154:157], v[52:55]
s_add_u32 m0, s47, 12288
ds_read_b128 a[68:71], v248 offset:26752
v_cvt_pk_bf16_f32 v238, v244, v245
v_mfma_f32_16x16x32_bf16 v[48:51], a[16:19], a[158:161], v[48:51]
ds_read_b128 a[0:3], v248 offset:26960
v_mul_f32 v246, v139, v35
v_mfma_f32_16x16x32_bf16 v[52:55], a[20:23], a[158:161], v[52:55]
ds_read_b64 a[114:115], v249 offset:26624
buffer_load_dwordx4 v253, s[28:31], m0 offen lds
v_mfma_f32_16x16x32_bf16 v[48:51], a[108:111], a[170:173], v[48:51]
ds_read_b64 a[118:119], v249 offset:26832
v_mul_f32 v247, v143, v39
v_cvt_pk_bf16_f32 v239, v246, v247
v_mfma_f32_16x16x32_bf16 v[52:55], a[110:113], a[168:171], v[52:55]
ds_read_b128 a[4:7], v251 offset:0
v_mul_f32 v244, v144, v40
v_mfma_f32_16x16x32_bf16 v[208:211], a[24:27], v[236:239], v[208:211]
s_waitcnt lgkmcnt(5)
ds_read_b128 a[8:11], v250 offset:6144
v_mul_f32 v245, v148, v44
v_mfma_f32_16x16x32_bf16 v[212:215], a[28:31], v[236:239], v[212:215]
s_add_u32 m0, s47, 53248
ds_read_b128 a[12:15], v251 offset:2048
buffer_load_dwordx4 v253, s[32:35], m0 offen lds
v_mfma_f32_16x16x32_bf16 v[216:219], a[32:35], v[236:239], v[216:219]
s_add_u32 m0, s47, 57344
ds_read_b128 a[16:19], v250 offset:8192
v_cvt_pk_bf16_f32 v240, v244, v245
v_mfma_f32_16x16x32_bf16 v[220:223], a[36:39], v[236:239], v[220:223]
ds_read_b128 a[20:23], v251 offset:4096
v_mul_f32 v246, v145, v41
v_mfma_f32_16x16x32_bf16 v[224:227], a[40:43], v[236:239], v[224:227]
ds_read_b128 a[24:27], v250 offset:10240
buffer_load_dwordx4 v253, s[32:35], m0 offen lds
v_mfma_f32_16x16x32_bf16 v[228:231], a[44:47], v[236:239], v[228:231]
s_add_u32 m0, s47, 61440
ds_read_b128 a[28:31], v252 offset:320
v_mul_f32 v247, v149, v45
v_mfma_f32_16x16x32_bf16 v[232:235], a[48:51], v[236:239], v[232:235]
ds_read_b128 a[32:35], v248 offset:33280
v_cvt_pk_bf16_f32 v241, v246, v247
v_mfma_f32_16x16x32_bf16 v[56:59], a[52:55], a[150:153], v[56:59]
ds_read_b128 a[36:39], v248 offset:33488
buffer_load_dwordx4 v253, s[32:35], m0 offen lds
v_mfma_f32_16x16x32_bf16 v[60:63], a[56:59], a[150:153], v[60:63]
s_add_u32 m0, s47, 65536
ds_read_b128 a[40:43], v248 offset:33344
v_mul_f32 v244, v146, v42
v_mfma_f32_16x16x32_bf16 v[56:59], a[60:63], a[154:157], v[56:59]
ds_read_b128 a[44:47], v248 offset:33552
v_mul_f32 v245, v150, v46
v_mfma_f32_16x16x32_bf16 v[60:63], a[64:67], a[154:157], v[60:63]
s_waitcnt lgkmcnt(5)
ds_read_b128 a[48:51], v248 offset:33408
buffer_load_dwordx4 v253, s[32:35], m0 offen lds
v_mfma_f32_16x16x32_bf16 v[56:59], a[68:71], a[158:161], v[56:59]
s_add_u32 m0, s47, 69632
ds_read_b128 a[52:55], v248 offset:33616
v_cvt_pk_bf16_f32 v242, v244, v245
v_mfma_f32_16x16x32_bf16 v[60:63], a[0:3], a[158:161], v[60:63]
ds_read_b64 a[120:121], v249 offset:33280
v_mul_f32 v246, v147, v43
v_mfma_f32_16x16x32_bf16 v[56:59], a[114:117], a[170:173], v[56:59]
s_waitcnt vmcnt(9) lgkmcnt(5)
ds_read_b64 a[124:125], v249 offset:33488
buffer_load_dwordx4 v253, s[32:35], m0 offen lds
v_mul_f32 v247, v151, v47
v_cvt_pk_bf16_f32 v243, v246, v247
v_mfma_f32_16x16x32_bf16 v[60:63], a[116:119], a[168:171], v[60:63]
s_barrier
ds_read_b128 a[56:59], v250 offset:12288
v_mfma_f32_16x16x32_bf16 v[208:211], a[4:7], v[240:243], v[208:211]
s_add_u32 m0, s48, 114048
ds_read_b128 a[60:63], v251 offset:6144
v_mul_f32 v244, v152, v48
v_mfma_f32_16x16x32_bf16 v[212:215], a[8:11], v[240:243], v[212:215]
ds_read_b128 a[64:67], v250 offset:14336
buffer_load_dwordx4 v254, s[24:27], s44 offen offset:640 lds
v_mfma_f32_16x16x32_bf16 v[216:219], a[12:15], v[240:243], v[216:219]
s_add_u32 m0, s48, 116096
ds_read_b128 a[68:71], v251 offset:8192
v_mul_f32 v245, v156, v52
v_mfma_f32_16x16x32_bf16 v[220:223], a[16:19], v[240:243], v[220:223]
ds_read_b128 a[0:3], v250 offset:16384
v_cvt_pk_bf16_f32 v236, v244, v245
v_mfma_f32_16x16x32_bf16 v[224:227], a[20:23], v[240:243], v[224:227]
ds_read_b128 a[4:7], v251 offset:10240
buffer_load_dwordx4 v254, s[24:27], s45 offen offset:640 lds
v_mfma_f32_16x16x32_bf16 v[228:231], a[24:27], v[240:243], v[228:231]
s_add_u32 m0, s48, 118144
ds_read_b128 a[8:11], v252 offset:384
v_mul_f32 v246, v153, v49
v_mfma_f32_16x16x32_bf16 v[232:235], a[28:31], v[240:243], v[232:235]
ds_read_b128 a[12:15], v248 offset:39936
v_mul_f32 v247, v157, v53
v_mfma_f32_16x16x32_bf16 v[64:67], a[32:35], a[150:153], v[64:67]
ds_read_b128 a[16:19], v248 offset:40144
buffer_load_dwordx4 v254, s[24:27], s46 offen offset:640 lds
v_mfma_f32_16x16x32_bf16 v[68:71], a[36:39], a[150:153], v[68:71]
s_waitcnt lgkmcnt(5)
ds_read_b128 a[20:23], v248 offset:40000
v_cvt_pk_bf16_f32 v237, v246, v247
v_mfma_f32_16x16x32_bf16 v[64:67], a[40:43], a[154:157], v[64:67]
s_add_u32 m0, s47, 16384
ds_read_b128 a[24:27], v248 offset:40208
v_mul_f32 v244, v154, v50
v_mfma_f32_16x16x32_bf16 v[68:71], a[44:47], a[154:157], v[68:71]
ds_read_b128 a[28:31], v248 offset:40064
buffer_load_dwordx4 v253, s[28:31], m0 offen lds
v_mfma_f32_16x16x32_bf16 v[64:67], a[48:51], a[158:161], v[64:67]
s_add_u32 m0, s47, 20480
ds_read_b128 a[32:35], v248 offset:40272
v_mul_f32 v245, v158, v54
v_mfma_f32_16x16x32_bf16 v[68:71], a[52:55], a[158:161], v[68:71]
ds_read_b64 a[126:127], v249 offset:39936
v_cvt_pk_bf16_f32 v238, v244, v245
v_mul_f32 v246, v155, v51
v_mfma_f32_16x16x32_bf16 v[64:67], a[120:123], a[170:173], v[64:67]
ds_read_b64 a[130:131], v249 offset:40144
buffer_load_dwordx4 v253, s[28:31], m0 offen lds
v_mul_f32 v247, v159, v55
v_cvt_pk_bf16_f32 v239, v246, v247
v_mfma_f32_16x16x32_bf16 v[68:71], a[122:125], a[168:171], v[68:71]
s_add_u32 m0, s47, 24576
ds_read_b128 a[36:39], v251 offset:12288
v_mul_f32 v244, v160, v56
v_mfma_f32_16x16x32_bf16 v[208:211], a[56:59], v[236:239], v[208:211]
ds_read_b128 a[40:43], v250 offset:18432
v_mul_f32 v245, v164, v60
v_mfma_f32_16x16x32_bf16 v[212:215], a[60:63], v[236:239], v[212:215]
ds_read_b128 a[44:47], v251 offset:14336
buffer_load_dwordx4 v253, s[28:31], m0 offen lds
v_mfma_f32_16x16x32_bf16 v[216:219], a[64:67], v[236:239], v[216:219]
s_add_u32 m0, s47, 28672
ds_read_b128 a[48:51], v250 offset:20480
v_cvt_pk_bf16_f32 v240, v244, v245
v_mfma_f32_16x16x32_bf16 v[220:223], a[68:71], v[236:239], v[220:223]
s_waitcnt lgkmcnt(5)
ds_read_b128 a[52:55], v251 offset:16384
v_mul_f32 v246, v161, v57
v_mfma_f32_16x16x32_bf16 v[224:227], a[0:3], v[236:239], v[224:227]
ds_read_b128 a[56:59], v250 offset:22528
buffer_load_dwordx4 v253, s[28:31], m0 offen lds
v_mfma_f32_16x16x32_bf16 v[228:231], a[4:7], v[236:239], v[228:231]
s_add_u32 m0, s47, 73728
ds_read_b128 a[60:63], v252 offset:448
v_mul_f32 v247, v165, v61
v_mfma_f32_16x16x32_bf16 v[232:235], a[8:11], v[236:239], v[232:235]
ds_read_b128 a[64:67], v248 offset:46592
v_cvt_pk_bf16_f32 v241, v246, v247
v_mfma_f32_16x16x32_bf16 v[72:75], a[12:15], a[150:153], v[72:75]
ds_read_b128 a[68:71], v248 offset:46800
buffer_load_dwordx4 v253, s[32:35], m0 offen lds
v_mfma_f32_16x16x32_bf16 v[76:79], a[16:19], a[150:153], v[76:79]
ds_read_b128 a[0:3], v248 offset:46656
v_mul_f32 v244, v162, v58
v_mfma_f32_16x16x32_bf16 v[72:75], a[20:23], a[154:157], v[72:75]
ds_read_b128 a[4:7], v248 offset:46864
v_mul_f32 v245, v166, v62
v_mfma_f32_16x16x32_bf16 v[76:79], a[24:27], a[154:157], v[76:79]
ds_read_b128 a[8:11], v248 offset:46720
v_cvt_pk_bf16_f32 v242, v244, v245
v_mfma_f32_16x16x32_bf16 v[72:75], a[28:31], a[158:161], v[72:75]
ds_read_b128 a[12:15], v248 offset:46928
v_mul_f32 v246, v163, v59
v_mfma_f32_16x16x32_bf16 v[76:79], a[32:35], a[158:161], v[76:79]
ds_read_b64 a[132:133], v249 offset:46592
v_mul_f32 v247, v167, v63
v_mfma_f32_16x16x32_bf16 v[72:75], a[126:129], a[170:173], v[72:75]
s_waitcnt lgkmcnt(5)
ds_read_b64 a[136:137], v249 offset:46800
v_cvt_pk_bf16_f32 v243, v246, v247
v_mfma_f32_16x16x32_bf16 v[76:79], a[128:131], a[168:171], v[76:79]
ds_read_b128 a[16:19], v250 offset:24576
v_mul_f32 v244, v168, v64
v_mfma_f32_16x16x32_bf16 v[208:211], a[36:39], v[240:243], v[208:211]
s_waitcnt vmcnt(6) lgkmcnt(5)
ds_read_b128 a[20:23], v251 offset:18432
v_mul_f32 v245, v172, v68
v_mfma_f32_16x16x32_bf16 v[212:215], a[40:43], v[240:243], v[212:215]
s_barrier
ds_read_b128 a[24:27], v250 offset:26624
v_mfma_f32_16x16x32_bf16 v[216:219], a[44:47], v[240:243], v[216:219]
s_add_u32 m0, s47, 32768
ds_read_b128 a[28:31], v251 offset:20480
buffer_load_dwordx4 v253, s[28:31], m0 offen lds
v_mfma_f32_16x16x32_bf16 v[220:223], a[48:51], v[240:243], v[220:223]
s_add_u32 m0, s47, 36864
ds_read_b128 a[32:35], v250 offset:28672
v_cvt_pk_bf16_f32 v236, v244, v245
v_mfma_f32_16x16x32_bf16 v[224:227], a[52:55], v[240:243], v[224:227]
ds_read_b128 a[36:39], v251 offset:22528
v_mul_f32 v246, v169, v65
v_mfma_f32_16x16x32_bf16 v[228:231], a[56:59], v[240:243], v[228:231]
ds_read_b128 a[40:43], v252 offset:512
buffer_load_dwordx4 v253, s[28:31], m0 offen lds
v_mfma_f32_16x16x32_bf16 v[232:235], a[60:63], v[240:243], v[232:235]
s_add_u32 m0, s47, 40960
ds_read_b128 a[44:47], v248 offset:0
v_mul_f32 v247, v173, v69
v_mfma_f32_16x16x32_bf16 v[80:83], a[64:67], a[150:153], v[80:83]
ds_read_b128 a[48:51], v248 offset:208
v_cvt_pk_bf16_f32 v237, v246, v247
v_mfma_f32_16x16x32_bf16 v[84:87], a[68:71], a[150:153], v[84:87]
ds_read_b128 a[52:55], v248 offset:64
buffer_load_dwordx4 v253, s[28:31], m0 offen lds
v_mfma_f32_16x16x32_bf16 v[80:83], a[0:3], a[154:157], v[80:83]
s_add_u32 m0, s47, 77824
ds_read_b128 a[56:59], v248 offset:272
v_mul_f32 v244, v170, v66
v_mfma_f32_16x16x32_bf16 v[84:87], a[4:7], a[154:157], v[84:87]
s_waitcnt lgkmcnt(5)
ds_read_b128 a[60:63], v248 offset:128
v_mul_f32 v245, v174, v70
v_mfma_f32_16x16x32_bf16 v[80:83], a[8:11], a[158:161], v[80:83]
ds_read_b128 a[64:67], v248 offset:336
buffer_load_dwordx4 v253, s[32:35], m0 offen lds
v_mfma_f32_16x16x32_bf16 v[84:87], a[12:15], a[158:161], v[84:87]
s_add_u32 m0, s47, 81920
ds_read_b64 a[138:139], v249 offset:0
v_cvt_pk_bf16_f32 v238, v244, v245
v_mul_f32 v246, v171, v67
v_mfma_f32_16x16x32_bf16 v[80:83], a[132:135], a[170:173], v[80:83]
ds_read_b64 a[142:143], v249 offset:208
v_mul_f32 v247, v175, v71
v_cvt_pk_bf16_f32 v239, v246, v247
v_mfma_f32_16x16x32_bf16 v[84:87], a[134:137], a[168:171], v[84:87]
ds_read_b128 a[68:71], v251 offset:24576
buffer_load_dwordx4 v253, s[32:35], m0 offen lds
v_mfma_f32_16x16x32_bf16 v[208:211], a[16:19], v[236:239], v[208:211]
s_add_u32 m0, s47, 86016
ds_read_b128 a[0:3], v250 offset:30720
v_mul_f32 v244, v176, v72
v_mfma_f32_16x16x32_bf16 v[212:215], a[20:23], v[236:239], v[212:215]
ds_read_b128 a[4:7], v251 offset:26624
v_mul_f32 v245, v180, v76
v_mfma_f32_16x16x32_bf16 v[216:219], a[24:27], v[236:239], v[216:219]
ds_read_b128 a[8:11], v250 offset:32768
buffer_load_dwordx4 v253, s[32:35], m0 offen lds
v_mfma_f32_16x16x32_bf16 v[220:223], a[28:31], v[236:239], v[220:223]
ds_read_b128 a[12:15], v251 offset:28672
v_cvt_pk_bf16_f32 v240, v244, v245
v_mfma_f32_16x16x32_bf16 v[224:227], a[32:35], v[236:239], v[224:227]
ds_read_b128 a[16:19], v250 offset:34816
v_mul_f32 v246, v177, v73
v_mfma_f32_16x16x32_bf16 v[228:231], a[36:39], v[236:239], v[228:231]
s_waitcnt lgkmcnt(5)
ds_read_b128 a[20:23], v252 offset:576
v_mul_f32 v247, v181, v77
v_mfma_f32_16x16x32_bf16 v[232:235], a[40:43], v[236:239], v[232:235]
ds_read_b128 a[24:27], v248 offset:6656
v_cvt_pk_bf16_f32 v241, v246, v247
v_mfma_f32_16x16x32_bf16 v[88:91], a[44:47], a[150:153], v[88:91]
ds_read_b128 a[28:31], v248 offset:6864
v_mul_f32 v244, v178, v74
v_mfma_f32_16x16x32_bf16 v[92:95], a[48:51], a[150:153], v[92:95]
ds_read_b128 a[32:35], v248 offset:6720
v_mul_f32 v245, v182, v78
v_mfma_f32_16x16x32_bf16 v[88:91], a[52:55], a[154:157], v[88:91]
ds_read_b128 a[36:39], v248 offset:6928
v_cvt_pk_bf16_f32 v242, v244, v245
v_mfma_f32_16x16x32_bf16 v[92:95], a[56:59], a[154:157], v[92:95]
ds_read_b128 a[40:43], v248 offset:6784
v_mul_f32 v246, v179, v75
v_mfma_f32_16x16x32_bf16 v[88:91], a[60:63], a[158:161], v[88:91]
ds_read_b128 a[44:47], v248 offset:6992
v_mul_f32 v247, v183, v79
v_mfma_f32_16x16x32_bf16 v[92:95], a[64:67], a[158:161], v[92:95]
ds_read_b64 a[144:145], v249 offset:6656
v_cvt_pk_bf16_f32 v243, v246, v247
v_mfma_f32_16x16x32_bf16 v[88:91], a[138:141], a[170:173], v[88:91]
ds_read_b64 a[148:149], v249 offset:6864
v_mul_f32 v244, v184, v80
v_mfma_f32_16x16x32_bf16 v[92:95], a[140:143], a[168:171], v[92:95]
ds_read_b128 a[48:51], v250 offset:36864
v_mul_f32 v245, v188, v84
v_mfma_f32_16x16x32_bf16 v[208:211], a[68:71], v[240:243], v[208:211]
s_waitcnt lgkmcnt(5)
ds_read_b128 a[52:55], v251 offset:30720
v_cvt_pk_bf16_f32 v236, v244, v245
v_mfma_f32_16x16x32_bf16 v[212:215], a[0:3], v[240:243], v[212:215]
ds_read_b128 a[56:59], v250 offset:38912
v_mul_f32 v246, v185, v81
v_mfma_f32_16x16x32_bf16 v[216:219], a[4:7], v[240:243], v[216:219]
s_waitcnt vmcnt(8) lgkmcnt(5)
ds_read_b128 a[60:63], v251 offset:32768
v_mul_f32 v247, v189, v85
v_mfma_f32_16x16x32_bf16 v[220:223], a[8:11], v[240:243], v[220:223]
s_barrier
ds_read_b128 a[64:67], v250 offset:40960
v_mfma_f32_16x16x32_bf16 v[224:227], a[12:15], v[240:243], v[224:227]
s_add_u32 m0, s47, 45056
ds_read_b128 a[68:71], v251 offset:34816
buffer_load_dwordx4 v253, s[28:31], m0 offen lds
v_mfma_f32_16x16x32_bf16 v[228:231], a[16:19], v[240:243], v[228:231]
s_add_u32 m0, s47, 49152
ds_read_b128 a[0:3], v252 offset:640
v_cvt_pk_bf16_f32 v237, v246, v247
v_mfma_f32_16x16x32_bf16 v[232:235], a[20:23], v[240:243], v[232:235]
L_pad5:
s_cbranch_vccnz L_rT
ds_read_b128 a[4:7], v251 offset:36864
v_mul_f32 v244, v186, v82
v_mfma_f32_16x16x32_bf16 v[96:99], a[24:27], a[150:153], v[96:99]
ds_read_b128 a[8:11], v250 offset:43008
buffer_load_dwordx4 v253, s[28:31], m0 offen lds
v_mfma_f32_16x16x32_bf16 v[100:103], a[28:31], a[150:153], v[100:103]
s_add_u32 m0, s47, 90112
ds_read_b128 a[12:15], v251 offset:38912
v_mul_f32 v245, v190, v86
v_mfma_f32_16x16x32_bf16 v[96:99], a[32:35], a[154:157], v[96:99]
ds_read_b128 a[16:19], v250 offset:45056
v_cvt_pk_bf16_f32 v238, v244, v245
v_mfma_f32_16x16x32_bf16 v[100:103], a[36:39], a[154:157], v[100:103]
ds_read_b128 a[20:23], v251 offset:40960
buffer_load_dwordx4 v253, s[32:35], m0 offen lds
v_mfma_f32_16x16x32_bf16 v[96:99], a[40:43], a[158:161], v[96:99]
s_add_u32 m0, s47, 94208
ds_read_b128 a[24:27], v250 offset:47104
v_mul_f32 v246, v187, v83
v_mfma_f32_16x16x32_bf16 v[100:103], a[44:47], a[158:161], v[100:103]
s_waitcnt lgkmcnt(5)
ds_read_b128 a[28:31], v252 offset:704
v_mul_f32 v247, v191, v87
v_mfma_f32_16x16x32_bf16 v[96:99], a[144:147], a[170:173], v[96:99]
ds_read_b128 a[32:35], v250 offset:49152
buffer_load_dwordx4 v253, s[32:35], m0 offen lds
v_cvt_pk_bf16_f32 v239, v246, v247
v_mfma_f32_16x16x32_bf16 v[100:103], a[146:149], a[168:171], v[100:103]
s_add_u32 m0, s47, 98304
ds_read_b128 a[36:39], v251 offset:43008
v_mul_f32 v244, v192, v88
v_mfma_f32_16x16x32_bf16 v[208:211], a[48:51], v[236:239], v[208:211]
ds_read_b128 a[40:43], v250 offset:51200
v_mul_f32 v245, v196, v92
v_mfma_f32_16x16x32_bf16 v[212:215], a[52:55], v[236:239], v[212:215]
ds_read_b128 a[44:47], v251 offset:45056
buffer_load_dwordx4 v253, s[32:35], m0 offen lds
v_cvt_pk_bf16_f32 v240, v244, v245
v_mul_f32 v246, v193, v89
v_mfma_f32_16x16x32_bf16 v[216:219], a[56:59], v[236:239], v[216:219]
ds_read_b128 a[48:51], v250 offset:53248
v_mul_f32 v247, v197, v93
v_cvt_pk_bf16_f32 v241, v246, v247
v_mfma_f32_16x16x32_bf16 v[220:223], a[60:63], v[236:239], v[220:223]
ds_read_b128 a[52:55], v251 offset:47104
v_mul_f32 v244, v194, v90
v_mul_f32 v245, v198, v94
v_mfma_f32_16x16x32_bf16 v[224:227], a[64:67], v[236:239], v[224:227]
ds_read_b128 a[56:59], v252 offset:768
v_cvt_pk_bf16_f32 v242, v244, v245
v_mul_f32 v246, v195, v91
v_mfma_f32_16x16x32_bf16 v[228:231], a[68:71], v[236:239], v[228:231]
ds_read_b128 a[60:63], v248 offset:13312
v_mul_f32 v247, v199, v95
v_cvt_pk_bf16_f32 v243, v246, v247
v_mfma_f32_16x16x32_bf16 v[232:235], a[0:3], v[236:239], v[232:235]
ds_read_b128 a[64:67], v248 offset:13520
v_mul_f32 v244, v200, v96
v_mfma_f32_16x16x32_bf16 v[208:211], a[4:7], v[240:243], v[208:211]
s_waitcnt lgkmcnt(5)
ds_read_b128 a[68:71], v248 offset:19968
v_mul_f32 v245, v204, v100
v_mfma_f32_16x16x32_bf16 v[212:215], a[8:11], v[240:243], v[212:215]
ds_read_b128 a[0:3], v248 offset:20176
v_cvt_pk_bf16_f32 v236, v244, v245
v_mul_f32 v246, v201, v97
v_mfma_f32_16x16x32_bf16 v[216:219], a[12:15], v[240:243], v[216:219]
ds_read_b128 a[4:7], v248 offset:13376
v_mul_f32 v247, v205, v101
v_cvt_pk_bf16_f32 v237, v246, v247
v_mfma_f32_16x16x32_bf16 v[220:223], a[16:19], v[240:243], v[220:223]
ds_read_b128 a[8:11], v248 offset:13584
v_mul_f32 v244, v202, v98
v_mul_f32 v245, v206, v102
v_mfma_f32_16x16x32_bf16 v[224:227], a[20:23], v[240:243], v[224:227]
ds_read_b128 a[12:15], v248 offset:20032
v_cvt_pk_bf16_f32 v238, v244, v245
v_mul_f32 v246, v203, v99
v_mfma_f32_16x16x32_bf16 v[228:231], a[24:27], v[240:243], v[228:231]
ds_read_b128 a[16:19], v248 offset:20240
v_mul_f32 v247, v207, v103
v_cvt_pk_bf16_f32 v239, v246, v247
v_mfma_f32_16x16x32_bf16 v[232:235], a[28:31], v[240:243], v[232:235]
ds_read_b128 a[20:23], v248 offset:13440
v_mfma_f32_16x16x32_bf16 v[208:211], a[32:35], v[236:239], v[208:211]
ds_read_b128 a[24:27], v248 offset:13648
v_mfma_f32_16x16x32_bf16 v[212:215], a[36:39], v[236:239], v[212:215]
ds_read_b128 a[28:31], v248 offset:20096
v_mfma_f32_16x16x32_bf16 v[216:219], a[40:43], v[236:239], v[216:219]
ds_read_b128 a[32:35], v248 offset:20304
v_mfma_f32_16x16x32_bf16 v[220:223], a[44:47], v[236:239], v[220:223]
s_waitcnt lgkmcnt(5)
ds_read_b64 a[72:73], v249 offset:13312
v_mfma_f32_16x16x32_bf16 v[224:227], a[48:51], v[236:239], v[224:227]
ds_read_b64 a[76:77], v249 offset:13520
v_cvt_pk_bf16_f32 v208, v208, v212
v_cvt_pk_bf16_f32 v209, v209, v213
v_cvt_pk_bf16_f32 v210, v210, v214
v_cvt_pk_bf16_f32 v211, v211, v215
v_accvgpr_write_b32 a150, v208
v_accvgpr_write_b32 a151, v209
v_mfma_f32_16x16x32_bf16 v[228:231], a[52:55], v[236:239], v[228:231]
ds_read_b64 a[78:79], v249 offset:19968
v_accvgpr_write_b32 a152, v210
v_accvgpr_write_b32 a153, v211
v_mfma_f32_16x16x32_bf16 v[232:235], a[56:59], v[236:239], v[232:235]
s_waitcnt vmcnt(4) lgkmcnt(5)
ds_read_b64 a[82:83], v249 offset:20176
v_cvt_pk_bf16_f32 v216, v216, v220
v_cvt_pk_bf16_f32 v217, v217, v221
v_mfma_f32_16x16x32_bf16 v[0:3], a[60:63], a[150:153], v[0:3]
s_barrier
ds_read_b128 a[36:39], v248 offset:26624
v_cvt_pk_bf16_f32 v218, v218, v222
v_cvt_pk_bf16_f32 v219, v219, v223
v_mfma_f32_16x16x32_bf16 v[4:7], a[64:67], a[150:153], v[4:7]
ds_read_b128 a[40:43], v248 offset:26832
v_accvgpr_write_b32 a154, v216
v_accvgpr_write_b32 a155, v217
v_mfma_f32_16x16x32_bf16 v[8:11], a[68:71], a[150:153], v[8:11]
ds_read_b128 a[44:47], v248 offset:26688
v_accvgpr_write_b32 a156, v218
v_accvgpr_write_b32 a157, v219
v_mfma_f32_16x16x32_bf16 v[12:15], a[0:3], a[150:153], v[12:15]
ds_read_b128 a[48:51], v248 offset:26896
v_cvt_pk_bf16_f32 v224, v224, v228
v_cvt_pk_bf16_f32 v225, v225, v229
v_mfma_f32_16x16x32_bf16 v[0:3], a[4:7], a[154:157], v[0:3]
ds_read_b128 a[52:55], v248 offset:26752
v_cvt_pk_bf16_f32 v226, v226, v230
v_cvt_pk_bf16_f32 v227, v227, v231
v_mfma_f32_16x16x32_bf16 v[4:7], a[8:11], a[154:157], v[4:7]
ds_read_b128 a[56:59], v248 offset:26960
v_accvgpr_write_b32 a158, v224
v_accvgpr_write_b32 a159, v225
v_mfma_f32_16x16x32_bf16 v[8:11], a[12:15], a[154:157], v[8:11]
ds_read_b64 a[84:85], v249 offset:26624
v_accvgpr_write_b32 a160, v226
v_accvgpr_write_b32 a161, v227
v_mfma_f32_16x16x32_bf16 v[12:15], a[16:19], a[154:157], v[12:15]
ds_read_b64 a[88:89], v249 offset:26832
v_cvt_pk_bf16_f32 v232, v232, v233
v_mfma_f32_16x16x32_bf16 v[0:3], a[20:23], a[158:161], v[0:3]
ds_read_b128 a[60:63], v248 offset:33280
v_cvt_pk_bf16_f32 v234, v234, v235
v_mfma_f32_16x16x32_bf16 v[4:7], a[24:27], a[158:161], v[4:7]
s_waitcnt lgkmcnt(5)
ds_read_b128 a[64:67], v248 offset:33488
v_cndmask_b32_e64 v232, 0, v232, s[56:57]
v_cndmask_b32_e64 v234, 0, v234, s[56:57]
v_mfma_f32_16x16x32_bf16 v[8:11], a[28:31], a[158:161], v[8:11]
ds_read_b128 a[68:71], v248 offset:33344
v_accvgpr_write_b32 a176, v232
v_accvgpr_write_b32 a177, v234
v_mfma_f32_16x16x32_bf16 v[12:15], a[32:35], a[158:161], v[12:15]
ds_read_b128 a[0:3], v248 offset:33552
v_add_u32 v250, 53248, v248
v_mfma_f32_16x16x32_bf16 v[0:3], a[72:75], a[176:179], v[0:3]
ds_read_b128 a[4:7], v248 offset:33408
v_add_u32 v251, 53248, v249
v_mfma_f32_16x16x32_bf16 v[4:7], a[74:77], a[174:177], v[4:7]
ds_read_b128 a[8:11], v248 offset:33616
v_mfma_f32_16x16x32_bf16 v[8:11], a[78:81], a[176:179], v[8:11]
ds_read_b64 a[90:91], v249 offset:33280
v_mfma_f32_16x16x32_bf16 v[12:15], a[80:83], a[174:177], v[12:15]
ds_read_b64 a[94:95], v249 offset:33488
v_mfma_f32_16x16x32_bf16 v[16:19], a[36:39], a[150:153], v[16:19]
ds_read_b128 a[12:15], v248 offset:39936
v_mul_f32 v244, v104, v0
v_mul_f32 v245, v108, v4
v_cvt_pk_bf16_f32 v236, v244, v245
v_mul_f32 v246, v105, v1
v_mul_f32 v247, v109, v5
v_cvt_pk_bf16_f32 v237, v246, v247
v_mul_f32 v244, v106, v2
v_mul_f32 v245, v110, v6
v_cvt_pk_bf16_f32 v238, v244, v245
v_mul_f32 v246, v107, v3
v_mfma_f32_16x16x32_bf16 v[20:23], a[40:43], a[150:153], v[20:23]
ds_read_b128 a[16:19], v248 offset:40144
v_mul_f32 v247, v111, v7
v_cvt_pk_bf16_f32 v239, v246, v247
v_mfma_f32_16x16x32_bf16 v[16:19], a[44:47], a[154:157], v[16:19]
ds_read_b128 a[20:23], v248 offset:40000
v_mul_f32 v244, v112, v8
v_mul_f32 v245, v116, v12
v_cvt_pk_bf16_f32 v208, v244, v245
v_mfma_f32_16x16x32_bf16 v[20:23], a[48:51], a[154:157], v[20:23]
s_waitcnt vmcnt(0) lgkmcnt(5)
ds_read_b128 a[24:27], v248 offset:40208
v_mul_f32 v246, v113, v9
v_mul_f32 v247, v117, v13
v_mfma_f32_16x16x32_bf16 v[16:19], a[52:55], a[158:161], v[16:19]
s_barrier
ds_read_b128 a[28:31], v248 offset:40064
v_cvt_pk_bf16_f32 v209, v246, v247
v_mul_f32 v244, v114, v10
v_mfma_f32_16x16x32_bf16 v[20:23], a[56:59], a[158:161], v[20:23]
ds_read_b128 a[32:35], v248 offset:40272
v_mul_f32 v245, v118, v14
v_cvt_pk_bf16_f32 v210, v244, v245
v_mfma_f32_16x16x32_bf16 v[16:19], a[84:87], a[176:179], v[16:19]
ds_read_b64 a[96:97], v249 offset:39936
v_mul_f32 v246, v115, v11
v_mul_f32 v247, v119, v15
v_mfma_f32_16x16x32_bf16 v[20:23], a[86:89], a[174:177], v[20:23]
ds_read_b64 a[100:101], v249 offset:40144
v_cvt_pk_bf16_f32 v211, v246, v247
s_mov_b64 vcc, s[62:63]
v_mfma_f32_16x16x32_bf16 v[24:27], a[60:63], a[150:153], v[24:27]
ds_read_b128 a[36:39], v248 offset:46592
v_cndmask_b32_dpp v240, v208, v236, vcc quad_perm:[1,0,3,2] row_mask:0xf bank_mask:0xf
v_cndmask_b32_dpp v241, v209, v237, vcc quad_perm:[1,0,3,2] row_mask:0xf bank_mask:0xf
v_mfma_f32_16x16x32_bf16 v[28:31], a[64:67], a[150:153], v[28:31]
ds_read_b128 a[40:43], v248 offset:46800
v_cndmask_b32_dpp v242, v210, v238, vcc quad_perm:[1,0,3,2] row_mask:0xf bank_mask:0xf
v_cndmask_b32_dpp v243, v211, v239, vcc quad_perm:[1,0,3,2] row_mask:0xf bank_mask:0xf
v_mfma_f32_16x16x32_bf16 v[24:27], a[68:71], a[154:157], v[24:27]
ds_read_b128 a[44:47], v248 offset:46656
buffer_store_dwordx4 v[240:243], v255, s[20:23], 0 offen offset:0 nt
v_mul_f32 v244, v120, v16
v_mul_f32 v245, v124, v20
v_cvt_pk_bf16_f32 v212, v244, v245
v_mfma_f32_16x16x32_bf16 v[28:31], a[0:3], a[154:157], v[28:31]
ds_read_b128 a[48:51], v248 offset:46864
v_mul_f32 v246, v121, v17
v_mul_f32 v247, v125, v21
v_mfma_f32_16x16x32_bf16 v[24:27], a[4:7], a[158:161], v[24:27]
ds_read_b128 a[52:55], v248 offset:46720
v_cvt_pk_bf16_f32 v213, v246, v247
v_mul_f32 v244, v122, v18
v_mfma_f32_16x16x32_bf16 v[28:31], a[8:11], a[158:161], v[28:31]
s_waitcnt lgkmcnt(5)
ds_read_b128 a[56:59], v248 offset:46928
v_mul_f32 v245, v126, v22
v_cvt_pk_bf16_f32 v214, v244, v245
v_mfma_f32_16x16x32_bf16 v[24:27], a[90:93], a[176:179], v[24:27]
ds_read_b64 a[102:103], v249 offset:46592
v_mul_f32 v246, v123, v19
v_mul_f32 v247, v127, v23
v_mfma_f32_16x16x32_bf16 v[28:31], a[92:95], a[174:177], v[28:31]
ds_read_b64 a[106:107], v249 offset:46800
v_cvt_pk_bf16_f32 v215, v246, v247
s_not_b64 vcc, vcc
v_mfma_f32_16x16x32_bf16 v[32:35], a[12:15], a[150:153], v[32:35]
ds_read_b128 a[60:63], v250 offset:0
v_cndmask_b32_dpp v208, v208, v212, vcc quad_perm:[1,0,3,2] row_mask:0xf bank_mask:0xf
v_cndmask_b32_dpp v209, v209, v213, vcc quad_perm:[1,0,3,2] row_mask:0xf bank_mask:0xf
v_mfma_f32_16x16x32_bf16 v[36:39], a[16:19], a[150:153], v[36:39]
ds_read_b128 a[64:67], v250 offset:208
v_cndmask_b32_dpp v210, v210, v214, vcc quad_perm:[1,0,3,2] row_mask:0xf bank_mask:0xf
v_cndmask_b32_dpp v211, v211, v215, vcc quad_perm:[1,0,3,2] row_mask:0xf bank_mask:0xf
v_mfma_f32_16x16x32_bf16 v[32:35], a[20:23], a[154:157], v[32:35]
ds_read_b128 a[68:71], v250 offset:64
buffer_store_dwordx4 v[208:211], v255, s[20:23], 0 offen offset:896 nt
v_mul_f32 v244, v128, v24
v_mul_f32 v245, v132, v28
v_cvt_pk_bf16_f32 v216, v244, v245
v_mfma_f32_16x16x32_bf16 v[36:39], a[24:27], a[154:157], v[36:39]
ds_read_b128 a[0:3], v250 offset:272
v_mul_f32 v246, v129, v25
v_mul_f32 v247, v133, v29
v_mfma_f32_16x16x32_bf16 v[32:35], a[28:31], a[158:161], v[32:35]
ds_read_b128 a[4:7], v250 offset:128
v_cvt_pk_bf16_f32 v217, v246, v247
v_mul_f32 v244, v130, v26
v_mfma_f32_16x16x32_bf16 v[36:39], a[32:35], a[158:161], v[36:39]
ds_read_b128 a[8:11], v250 offset:336
v_mul_f32 v245, v134, v30
v_cvt_pk_bf16_f32 v218, v244, v245
v_mfma_f32_16x16x32_bf16 v[32:35], a[96:99], a[176:179], v[32:35]
ds_read_b64 a[108:109], v251 offset:0
v_mul_f32 v246, v131, v27
v_mul_f32 v247, v135, v31
v_mfma_f32_16x16x32_bf16 v[36:39], a[98:101], a[174:177], v[36:39]
s_waitcnt lgkmcnt(5)
ds_read_b64 a[112:113], v251 offset:208
v_cvt_pk_bf16_f32 v219, v246, v247
s_not_b64 vcc, vcc
v_mfma_f32_16x16x32_bf16 v[40:43], a[36:39], a[150:153], v[40:43]
ds_read_b128 a[12:15], v250 offset:6656
v_cndmask_b32_dpp v212, v216, v212, vcc quad_perm:[1,0,3,2] row_mask:0xf bank_mask:0xf
v_cndmask_b32_dpp v213, v217, v213, vcc quad_perm:[1,0,3,2] row_mask:0xf bank_mask:0xf
v_mfma_f32_16x16x32_bf16 v[44:47], a[40:43], a[150:153], v[44:47]
ds_read_b128 a[16:19], v250 offset:6864
v_cndmask_b32_dpp v214, v218, v214, vcc quad_perm:[1,0,3,2] row_mask:0xf bank_mask:0xf
v_cndmask_b32_dpp v215, v219, v215, vcc quad_perm:[1,0,3,2] row_mask:0xf bank_mask:0xf
v_mfma_f32_16x16x32_bf16 v[40:43], a[44:47], a[154:157], v[40:43]
ds_read_b128 a[20:23], v250 offset:6720
buffer_store_dwordx4 v[212:215], v255, s[20:23], 0 offen offset:128 nt
v_mul_f32 v244, v136, v32
v_mul_f32 v245, v140, v36
v_cvt_pk_bf16_f32 v220, v244, v245
v_mfma_f32_16x16x32_bf16 v[44:47], a[48:51], a[154:157], v[44:47]
ds_read_b128 a[24:27], v250 offset:6928
v_mul_f32 v246, v137, v33
v_mul_f32 v247, v141, v37
v_mfma_f32_16x16x32_bf16 v[40:43], a[52:55], a[158:161], v[40:43]
ds_read_b128 a[28:31], v250 offset:6784
v_cvt_pk_bf16_f32 v221, v246, v247
v_mul_f32 v244, v138, v34
v_mfma_f32_16x16x32_bf16 v[44:47], a[56:59], a[158:161], v[44:47]
ds_read_b128 a[32:35], v250 offset:6992
v_mul_f32 v245, v142, v38
v_cvt_pk_bf16_f32 v222, v244, v245
v_mfma_f32_16x16x32_bf16 v[40:43], a[102:105], a[176:179], v[40:43]
ds_read_b64 a[114:115], v251 offset:6656
v_mul_f32 v246, v139, v35
v_mul_f32 v247, v143, v39
v_mfma_f32_16x16x32_bf16 v[44:47], a[104:107], a[174:177], v[44:47]
ds_read_b64 a[118:119], v251 offset:6864
v_cvt_pk_bf16_f32 v223, v246, v247
s_not_b64 vcc, vcc
v_mfma_f32_16x16x32_bf16 v[48:51], a[60:63], a[150:153], v[48:51]
ds_read_b128 a[36:39], v250 offset:13312
v_cndmask_b32_dpp v216, v216, v220, vcc quad_perm:[1,0,3,2] row_mask:0xf bank_mask:0xf
v_cndmask_b32_dpp v217, v217, v221, vcc quad_perm:[1,0,3,2] row_mask:0xf bank_mask:0xf
v_mfma_f32_16x16x32_bf16 v[52:55], a[64:67], a[150:153], v[52:55]
s_waitcnt lgkmcnt(5)
ds_read_b128 a[40:43], v250 offset:13520
v_cndmask_b32_dpp v218, v218, v222, vcc quad_perm:[1,0,3,2] row_mask:0xf bank_mask:0xf
v_cndmask_b32_dpp v219, v219, v223, vcc quad_perm:[1,0,3,2] row_mask:0xf bank_mask:0xf
v_mfma_f32_16x16x32_bf16 v[48:51], a[68:71], a[154:157], v[48:51]
ds_read_b128 a[44:47], v250 offset:13376
buffer_store_dwordx4 v[216:219], v255, s[20:23], 0 offen offset:1024 nt
v_mul_f32 v244, v144, v40
v_mul_f32 v245, v148, v44
v_cvt_pk_bf16_f32 v224, v244, v245
v_mfma_f32_16x16x32_bf16 v[52:55], a[0:3], a[154:157], v[52:55]
ds_read_b128 a[48:51], v250 offset:13584
v_mul_f32 v246, v145, v41
v_mul_f32 v247, v149, v45
v_mfma_f32_16x16x32_bf16 v[48:51], a[4:7], a[158:161], v[48:51]
ds_read_b128 a[52:55], v250 offset:13440
v_cvt_pk_bf16_f32 v225, v246, v247
v_mul_f32 v244, v146, v42
v_mfma_f32_16x16x32_bf16 v[52:55], a[8:11], a[158:161], v[52:55]
ds_read_b128 a[56:59], v250 offset:13648
v_mul_f32 v245, v150, v46
v_cvt_pk_bf16_f32 v226, v244, v245
v_mfma_f32_16x16x32_bf16 v[48:51], a[108:111], a[176:179], v[48:51]
ds_read_b64 a[120:121], v251 offset:13312
v_mul_f32 v246, v147, v43
v_mul_f32 v247, v151, v47
v_mfma_f32_16x16x32_bf16 v[52:55], a[110:113], a[174:177], v[52:55]
ds_read_b64 a[124:125], v251 offset:13520
v_cvt_pk_bf16_f32 v227, v246, v247
s_not_b64 vcc, vcc
v_mfma_f32_16x16x32_bf16 v[56:59], a[12:15], a[150:153], v[56:59]
ds_read_b128 a[60:63], v250 offset:19968
v_cndmask_b32_dpp v220, v224, v220, vcc quad_perm:[1,0,3,2] row_mask:0xf bank_mask:0xf
v_cndmask_b32_dpp v221, v225, v221, vcc quad_perm:[1,0,3,2] row_mask:0xf bank_mask:0xf
v_mfma_f32_16x16x32_bf16 v[60:63], a[16:19], a[150:153], v[60:63]
ds_read_b128 a[64:67], v250 offset:20176
v_cndmask_b32_dpp v222, v226, v222, vcc quad_perm:[1,0,3,2] row_mask:0xf bank_mask:0xf
v_cndmask_b32_dpp v223, v227, v223, vcc quad_perm:[1,0,3,2] row_mask:0xf bank_mask:0xf
v_mfma_f32_16x16x32_bf16 v[56:59], a[20:23], a[154:157], v[56:59]
ds_read_b128 a[68:71], v250 offset:20032
buffer_store_dwordx4 v[220:223], v255, s[20:23], 0 offen offset:256 nt
v_mul_f32 v244, v152, v48
v_mul_f32 v245, v156, v52
v_cvt_pk_bf16_f32 v228, v244, v245
v_mfma_f32_16x16x32_bf16 v[60:63], a[24:27], a[154:157], v[60:63]
s_waitcnt lgkmcnt(5)
ds_read_b128 a[0:3], v250 offset:20240
v_mul_f32 v246, v153, v49
v_mul_f32 v247, v157, v53
v_mfma_f32_16x16x32_bf16 v[56:59], a[28:31], a[158:161], v[56:59]
ds_read_b128 a[4:7], v250 offset:20096
v_cvt_pk_bf16_f32 v229, v246, v247
v_mul_f32 v244, v154, v50
v_mfma_f32_16x16x32_bf16 v[60:63], a[32:35], a[158:161], v[60:63]
ds_read_b128 a[8:11], v250 offset:20304
v_mul_f32 v245, v158, v54
v_cvt_pk_bf16_f32 v230, v244, v245
v_mfma_f32_16x16x32_bf16 v[56:59], a[114:117], a[176:179], v[56:59]
ds_read_b64 a[126:127], v251 offset:19968
v_mul_f32 v246, v155, v51
v_mul_f32 v247, v159, v55
v_mfma_f32_16x16x32_bf16 v[60:63], a[116:119], a[174:177], v[60:63]
ds_read_b64 a[130:131], v251 offset:20176
v_cvt_pk_bf16_f32 v231, v246, v247
s_not_b64 vcc, vcc
v_mfma_f32_16x16x32_bf16 v[64:67], a[36:39], a[150:153], v[64:67]
ds_read_b128 a[12:15], v250 offset:26624
v_cndmask_b32_dpp v224, v224, v228, vcc quad_perm:[1,0,3,2] row_mask:0xf bank_mask:0xf
v_cndmask_b32_dpp v225, v225, v229, vcc quad_perm:[1,0,3,2] row_mask:0xf bank_mask:0xf
v_mfma_f32_16x16x32_bf16 v[68:71], a[40:43], a[150:153], v[68:71]
ds_read_b128 a[16:19], v250 offset:26832
v_cndmask_b32_dpp v226, v226, v230, vcc quad_perm:[1,0,3,2] row_mask:0xf bank_mask:0xf
v_cndmask_b32_dpp v227, v227, v231, vcc quad_perm:[1,0,3,2] row_mask:0xf bank_mask:0xf
v_mfma_f32_16x16x32_bf16 v[64:67], a[44:47], a[154:157], v[64:67]
ds_read_b128 a[20:23], v250 offset:26688
buffer_store_dwordx4 v[224:227], v255, s[20:23], 0 offen offset:1152 nt
v_mul_f32 v244, v160, v56
v_mul_f32 v245, v164, v60
v_cvt_pk_bf16_f32 v232, v244, v245
v_mfma_f32_16x16x32_bf16 v[68:71], a[48:51], a[154:157], v[68:71]
ds_read_b128 a[24:27], v250 offset:26896
v_mul_f32 v246, v161, v57
v_mul_f32 v247, v165, v61
v_mfma_f32_16x16x32_bf16 v[64:67], a[52:55], a[158:161], v[64:67]
ds_read_b128 a[28:31], v250 offset:26752
v_cvt_pk_bf16_f32 v233, v246, v247
v_mul_f32 v244, v162, v58
v_mfma_f32_16x16x32_bf16 v[68:71], a[56:59], a[158:161], v[68:71]
s_waitcnt lgkmcnt(5)
ds_read_b128 a[32:35], v250 offset:26960
v_mul_f32 v245, v166, v62
v_cvt_pk_bf16_f32 v234, v244, v245
v_mfma_f32_16x16x32_bf16 v[64:67], a[120:123], a[176:179], v[64:67]
ds_read_b64 a[132:133], v251 offset:26624
v_mul_f32 v246, v163, v59
v_mul_f32 v247, v167, v63
v_mfma_f32_16x16x32_bf16 v[68:71], a[122:125], a[174:177], v[68:71]
ds_read_b64 a[136:137], v251 offset:26832
v_cvt_pk_bf16_f32 v235, v246, v247
s_not_b64 vcc, vcc
v_mfma_f32_16x16x32_bf16 v[72:75], a[60:63], a[150:153], v[72:75]
ds_read_b128 a[36:39], v250 offset:33280
v_cndmask_b32_dpp v228, v232, v228, vcc quad_perm:[1,0,3,2] row_mask:0xf bank_mask:0xf
v_cndmask_b32_dpp v229, v233, v229, vcc quad_perm:[1,0,3,2] row_mask:0xf bank_mask:0xf
v_mfma_f32_16x16x32_bf16 v[76:79], a[64:67], a[150:153], v[76:79]
ds_read_b128 a[40:43], v250 offset:33488
v_cndmask_b32_dpp v230, v234, v230, vcc quad_perm:[1,0,3,2] row_mask:0xf bank_mask:0xf
v_cndmask_b32_dpp v231, v235, v231, vcc quad_perm:[1,0,3,2] row_mask:0xf bank_mask:0xf
v_mfma_f32_16x16x32_bf16 v[72:75], a[68:71], a[154:157], v[72:75]
ds_read_b128 a[44:47], v250 offset:33344
buffer_store_dwordx4 v[228:231], v255, s[20:23], 0 offen offset:384 nt
v_mul_f32 v244, v168, v64
v_mul_f32 v245, v172, v68
v_cvt_pk_bf16_f32 v208, v244, v245
v_mfma_f32_16x16x32_bf16 v[76:79], a[0:3], a[154:157], v[76:79]
ds_read_b128 a[48:51], v250 offset:33552
v_mul_f32 v246, v169, v65
v_mul_f32 v247, v173, v69
v_mfma_f32_16x16x32_bf16 v[72:75], a[4:7], a[158:161], v[72:75]
ds_read_b128 a[52:55], v250 offset:33408
v_cvt_pk_bf16_f32 v209, v246, v247
v_mul_f32 v244, v170, v66
v_mfma_f32_16x16x32_bf16 v[76:79], a[8:11], a[158:161], v[76:79]
ds_read_b128 a[56:59], v250 offset:33616
v_mul_f32 v245, v174, v70
v_cvt_pk_bf16_f32 v210, v244, v245
v_mfma_f32_16x16x32_bf16 v[72:75], a[126:129], a[176:179], v[72:75]
ds_read_b64 a[138:139], v251 offset:33280
v_mul_f32 v246, v171, v67
v_mul_f32 v247, v175, v71
v_mfma_f32_16x16x32_bf16 v[76:79], a[128:131], a[174:177], v[76:79]
s_waitcnt lgkmcnt(5)
ds_read_b64 a[142:143], v251 offset:33488
v_cvt_pk_bf16_f32 v211, v246, v247
s_not_b64 vcc, vcc
v_mfma_f32_16x16x32_bf16 v[80:83], a[12:15], a[150:153], v[80:83]
ds_read_b128 a[60:63], v250 offset:39936
v_cndmask_b32_dpp v232, v232, v208, vcc quad_perm:[1,0,3,2] row_mask:0xf bank_mask:0xf
v_cndmask_b32_dpp v233, v233, v209, vcc quad_perm:[1,0,3,2] row_mask:0xf bank_mask:0xf
v_mfma_f32_16x16x32_bf16 v[84:87], a[16:19], a[150:153], v[84:87]
ds_read_b128 a[64:67], v250 offset:40144
v_cndmask_b32_dpp v234, v234, v210, vcc quad_perm:[1,0,3,2] row_mask:0xf bank_mask:0xf
v_cndmask_b32_dpp v235, v235, v211, vcc quad_perm:[1,0,3,2] row_mask:0xf bank_mask:0xf
v_mfma_f32_16x16x32_bf16 v[80:83], a[20:23], a[154:157], v[80:83]
ds_read_b128 a[68:71], v250 offset:40000
buffer_store_dwordx4 v[232:235], v255, s[20:23], 0 offen offset:1280 nt
v_mul_f32 v244, v176, v72
v_mul_f32 v245, v180, v76
v_cvt_pk_bf16_f32 v212, v244, v245
v_mfma_f32_16x16x32_bf16 v[84:87], a[24:27], a[154:157], v[84:87]
ds_read_b128 a[0:3], v250 offset:40208
v_mul_f32 v246, v177, v73
v_mul_f32 v247, v181, v77
v_mfma_f32_16x16x32_bf16 v[80:83], a[28:31], a[158:161], v[80:83]
ds_read_b128 a[4:7], v250 offset:40064
v_cvt_pk_bf16_f32 v213, v246, v247
v_mul_f32 v244, v178, v74
v_mfma_f32_16x16x32_bf16 v[84:87], a[32:35], a[158:161], v[84:87]
ds_read_b128 a[8:11], v250 offset:40272
v_mul_f32 v245, v182, v78
v_cvt_pk_bf16_f32 v214, v244, v245
v_mfma_f32_16x16x32_bf16 v[80:83], a[132:135], a[176:179], v[80:83]
ds_read_b64 a[144:145], v251 offset:39936
v_mul_f32 v246, v179, v75
v_mul_f32 v247, v183, v79
v_mfma_f32_16x16x32_bf16 v[84:87], a[134:137], a[174:177], v[84:87]
ds_read_b64 a[148:149], v251 offset:40144
v_cvt_pk_bf16_f32 v215, v246, v247
s_not_b64 vcc, vcc
v_mfma_f32_16x16x32_bf16 v[88:91], a[36:39], a[150:153], v[88:91]
v_cndmask_b32_dpp v208, v212, v208, vcc quad_perm:[1,0,3,2] row_mask:0xf bank_mask:0xf
v_cndmask_b32_dpp v209, v213, v209, vcc quad_perm:[1,0,3,2] row_mask:0xf bank_mask:0xf
v_mfma_f32_16x16x32_bf16 v[92:95], a[40:43], a[150:153], v[92:95]
s_waitcnt lgkmcnt(4)
v_cndmask_b32_dpp v210, v214, v210, vcc quad_perm:[1,0,3,2] row_mask:0xf bank_mask:0xf
v_cndmask_b32_dpp v211, v215, v211, vcc quad_perm:[1,0,3,2] row_mask:0xf bank_mask:0xf
v_mfma_f32_16x16x32_bf16 v[88:91], a[44:47], a[154:157], v[88:91]
buffer_store_dwordx4 v[208:211], v255, s[20:23], 0 offen offset:512 nt
v_mul_f32 v244, v184, v80
v_mul_f32 v245, v188, v84
v_cvt_pk_bf16_f32 v216, v244, v245
v_mfma_f32_16x16x32_bf16 v[92:95], a[48:51], a[154:157], v[92:95]
v_mul_f32 v246, v185, v81
v_mul_f32 v247, v189, v85
v_mfma_f32_16x16x32_bf16 v[88:91], a[52:55], a[158:161], v[88:91]
v_cvt_pk_bf16_f32 v217, v246, v247
v_mul_f32 v244, v186, v82
v_mfma_f32_16x16x32_bf16 v[92:95], a[56:59], a[158:161], v[92:95]
v_mul_f32 v245, v190, v86
v_cvt_pk_bf16_f32 v218, v244, v245
v_mfma_f32_16x16x32_bf16 v[88:91], a[138:141], a[176:179], v[88:91]
v_mul_f32 v246, v187, v83
v_mul_f32 v247, v191, v87
v_mfma_f32_16x16x32_bf16 v[92:95], a[140:143], a[174:177], v[92:95]
v_cvt_pk_bf16_f32 v219, v246, v247
s_not_b64 vcc, vcc
v_mfma_f32_16x16x32_bf16 v[96:99], a[60:63], a[150:153], v[96:99]
v_cndmask_b32_dpp v212, v212, v216, vcc quad_perm:[1,0,3,2] row_mask:0xf bank_mask:0xf
v_cndmask_b32_dpp v213, v213, v217, vcc quad_perm:[1,0,3,2] row_mask:0xf bank_mask:0xf
v_mfma_f32_16x16x32_bf16 v[100:103], a[64:67], a[150:153], v[100:103]
v_cndmask_b32_dpp v214, v214, v218, vcc quad_perm:[1,0,3,2] row_mask:0xf bank_mask:0xf
v_cndmask_b32_dpp v215, v215, v219, vcc quad_perm:[1,0,3,2] row_mask:0xf bank_mask:0xf
v_mfma_f32_16x16x32_bf16 v[96:99], a[68:71], a[154:157], v[96:99]
buffer_store_dwordx4 v[212:215], v255, s[20:23], 0 offen offset:1408 nt
v_mul_f32 v244, v192, v88
v_mul_f32 v245, v196, v92
v_cvt_pk_bf16_f32 v220, v244, v245
v_mul_f32 v246, v193, v89
v_mul_f32 v247, v197, v93
v_cvt_pk_bf16_f32 v221, v246, v247
v_mul_f32 v244, v194, v90
v_mul_f32 v245, v198, v94
v_cvt_pk_bf16_f32 v222, v244, v245
v_mfma_f32_16x16x32_bf16 v[100:103], a[0:3], a[154:157], v[100:103]
s_waitcnt lgkmcnt(0)
v_mul_f32 v246, v195, v91
v_mul_f32 v247, v199, v95
v_mfma_f32_16x16x32_bf16 v[96:99], a[4:7], a[158:161], v[96:99]
v_cvt_pk_bf16_f32 v223, v246, v247
s_not_b64 vcc, vcc
v_mfma_f32_16x16x32_bf16 v[100:103], a[8:11], a[158:161], v[100:103]
v_cndmask_b32_dpp v216, v220, v216, vcc quad_perm:[1,0,3,2] row_mask:0xf bank_mask:0xf
v_cndmask_b32_dpp v217, v221, v217, vcc quad_perm:[1,0,3,2] row_mask:0xf bank_mask:0xf
v_mfma_f32_16x16x32_bf16 v[96:99], a[144:147], a[176:179], v[96:99]
v_cndmask_b32_dpp v218, v222, v218, vcc quad_perm:[1,0,3,2] row_mask:0xf bank_mask:0xf
v_cndmask_b32_dpp v219, v223, v219, vcc quad_perm:[1,0,3,2] row_mask:0xf bank_mask:0xf
v_mfma_f32_16x16x32_bf16 v[100:103], a[146:149], a[174:177], v[100:103]
buffer_store_dwordx4 v[216:219], v255, s[20:23], 0 offen offset:640 nt
s_nop 3
v_mul_f32 v244, v200, v96
s_nop 1
v_mul_f32 v245, v204, v100
v_cvt_pk_bf16_f32 v224, v244, v245
v_mul_f32 v246, v201, v97
v_mul_f32 v247, v205, v101
v_cvt_pk_bf16_f32 v225, v246, v247
v_mul_f32 v244, v202, v98
v_mul_f32 v245, v206, v102
v_cvt_pk_bf16_f32 v226, v244, v245
v_mul_f32 v246, v203, v99
v_mul_f32 v247, v207, v103
v_cvt_pk_bf16_f32 v227, v246, v247
s_not_b64 vcc, vcc
v_cndmask_b32_dpp v220, v220, v224, vcc quad_perm:[1,0,3,2] row_mask:0xf bank_mask:0xf
v_cndmask_b32_dpp v221, v221, v225, vcc quad_perm:[1,0,3,2] row_mask:0xf bank_mask:0xf
v_cndmask_b32_dpp v222, v222, v226, vcc quad_perm:[1,0,3,2] row_mask:0xf bank_mask:0xf
v_cndmask_b32_dpp v223, v223, v227, vcc quad_perm:[1,0,3,2] row_mask:0xf bank_mask:0xf
buffer_store_dwordx4 v[220:223], v255, s[20:23], 0 offen offset:1536 nt
v_cndmask_b32 v236, v224, v236, vcc
v_cndmask_b32 v237, v225, v237, vcc
v_cndmask_b32 v238, v226, v238, vcc
v_cndmask_b32 v239, v227, v239, vcc
buffer_store_dwordx4 v[236:239], v255, s[20:23], 0 offen offset:768 nt
L_end:
s_endpgm
.section .rodata,"a"
.p2align 6
.amdhsa_kernel standalone__cross_network_dcn_v2__recsys_kernel
  .amdhsa_next_free_vgpr 512
  .amdhsa_next_free_sgpr 102
  .amdhsa_accum_offset 256
  .amdhsa_group_segment_fixed_size 0
  .amdhsa_kernarg_size 56
  .amdhsa_user_sgpr_count 2
  .amdhsa_user_sgpr_kernarg_segment_ptr 1
  .amdhsa_system_sgpr_workgroup_id_x 1
.end_amdhsa_kernel
```
